```python
import torch

def _softmax(x, axis=-1):
    return torch.softmax(x, dim=axis)
def _gelu(x):
    return torch.nn.functional.gelu(x, approximate="tanh")
def _silu(x):
    return torch.nn.functional.silu(x)
def _sigmoid(x):
    return torch.sigmoid(x)
def _layernorm(x, axis=-1, eps=1e-5):
    m = x.mean(dim=axis, keepdim=True)
    v = x.var(dim=axis, keepdim=True, unbiased=False)
    return (x - m) / torch.sqrt(v + eps)
def _scatter_add(tgt, idx, src, axis=0):
    return tgt.clone().index_add_(axis, idx, src)
def _segment_sum(src, seg, n):
    out = torch.zeros((n,) + src.shape[1:], dtype=src.dtype)
    return out.index_add_(0, seg, src)
def _pad(x, pw):
    flat = tuple(v for pair in reversed(pw) for v in pair)
    return torch.nn.functional.pad(x, flat)

kernel_name = 'standalone__molecular_angular_gemnet__graph'

def setup_inputs():

    _w = (lambda a: (lambda t: t.to(torch.bfloat16) if t.is_floating_point() else t)(torch.as_tensor(a)))
    N, deg, De, L = 10000, 32, 4, 1
    E = N * deg
    T = E * deg
    NR = 8
    dist = torch.rand(E).to(float)
    angle = (torch.rand(T) * torch.pi).to(float)
    centers = torch.linspace(0.0, 1.0, NR).to(float)
    ang_freq = torch.arange(1, L + 1).to(float)
    return {
        "m": _w((lambda *s: torch.randn(*s, dtype=torch.bfloat16) * 0.05)(E, De)),
        "idx_in": _w((lambda lo, hi, *s: torch.randint(lo, hi, s))(0, E, T).to(torch.int64)),
        "idx_out": _w((lambda lo, hi, *s: torch.randint(lo, hi, s))(0, E, T).to(torch.int64)),
        "dist": _w(dist),
        "angle": _w(angle),
        "centers": _w(centers),
        "ang_freq": _w(ang_freq),
        "w_rbf": _w((lambda *s: torch.randn(*s, dtype=torch.bfloat16) * 0.4)(NR, De)),
        "w_sbf": _w((lambda *s: torch.randn(*s, dtype=torch.bfloat16) * 0.4)(NR * L, De)),
        "w_down": _w((lambda *s: torch.randn(*s, dtype=torch.bfloat16) * 0.4)(De, De)),
        "w_up": _w((lambda *s: torch.randn(*s, dtype=torch.bfloat16) * 0.4)(De, De)),
    }

def reference(m, idx_in, idx_out, dist, angle, centers, ang_freq, w_rbf, w_sbf, w_down, w_up):
    E, De = m.shape[0], m.shape[1]
    NR = centers.shape[0]
    L = ang_freq.shape[0]
    rbf = torch.exp(-10.0 * (dist[:, None] - centers[None, :]) ** 2)
    cbf = torch.cos(ang_freq[None, :] * angle[:, None])
    rbf_t = rbf[idx_out]
    sbf = torch.reshape(rbf_t[:, :, None] * cbf[:, None, :], (-1, NR * L))
    x = (m[idx_in] @ w_down) * (sbf @ w_sbf)
    agg = _segment_sum(x, idx_out, E)
    return m + (agg @ w_up) * (rbf @ w_rbf)
```

```asm
; @launch kernel=gem_part_kernel grid=(250,1,1) block=(1024,1,1) lds=155008
; @launch kernel=gem_acc_kernel grid=(256,1,1) block=(1024,1,1) lds=145664
.amdgcn_target "amdgcn-amd-amdhsa--gfx950"
.text
.globl gem_part_kernel
.p2align 8
.type gem_part_kernel,@function
gem_part_kernel:
    s_cmp_ge_u32 s2, 250
    s_cbranch_scc1 gem_part_kernel_end
    s_load_dwordx4 s[4:7], s[0:1], 0
    s_load_dwordx2 s[8:9], s[0:1], 16
    s_load_dwordx2 s[10:11], s[0:1], 32
    s_load_dwordx2 s[12:13], s[0:1], 48
    s_load_dwordx2 s[14:15], s[0:1], 72
    s_load_dwordx2 s[16:17], s[0:1], 104
    v_lshlrev_b32 v1, 4, v0
    v_lshlrev_b32 v2, 3, v0
    v_lshlrev_b32 v3, 2, v0
    v_lshrrev_b32 v108, 6, v0
    v_mov_b32 v5, 1
    v_readfirstlane_b32 s48, v108
    s_mul_i32 s18, s2, 163840
    s_mul_i32 s19, s2, 81920
    s_cmp_eq_u32 s48, 15
    s_cbranch_scc0 gem_part_kernel_nopf
    s_cmp_lt_u32 s2, 16
    s_cbranch_scc0 gem_part_kernel_nopf
    v_and_b32 v120, 63, v0
    s_getpc_b64 s[66:67]
gem_part_kernel_pf_pc:
    s_add_u32 s66, s66, gem_part_kernel_pfbase-gem_part_kernel_pf_pc
    s_addc_u32 s67, s67, 0
    v_lshlrev_b32 v121, 7, v120
    v_min_u32 v121, gem_acc_kernel_end-gem_part_kernel_pfbase, v121
    global_load_dword v7, v121, s[66:67]
    v_add_u32 v121, 8192, v121
    v_min_u32 v121, gem_acc_kernel_end-gem_part_kernel_pfbase, v121
    global_load_dword v7, v121, s[66:67]
    v_add_u32 v121, 8192, v121
    v_min_u32 v121, gem_acc_kernel_end-gem_part_kernel_pfbase, v121
    global_load_dword v7, v121, s[66:67]
    v_add_u32 v121, 8192, v121
    v_min_u32 v121, gem_acc_kernel_end-gem_part_kernel_pfbase, v121
    global_load_dword v7, v121, s[66:67]
gem_part_kernel_nopf:
gem_part_kernel_pfbase:
    v_mov_b32 v108, 0
    v_mov_b32 v109, 0
    v_mov_b32 v110, 0
    v_mov_b32 v111, 0
    ds_write_b128 v1, v[108:111]
    v_cmp_gt_u32 vcc, 264, v0
    s_and_saveexec_b64 s[52:53], vcc
    ds_write_b128 v1, v[108:111] offset:16384
    s_mov_b64 exec, s[52:53]
    s_waitcnt lgkmcnt(0)
    s_add_u32 s6, s6, s18
    s_addc_u32 s7, s7, 0
    s_add_u32 s8, s8, s18
    s_addc_u32 s9, s9, 0
    s_add_u32 s10, s10, s19
    s_addc_u32 s11, s11, 0
    s_add_u32 s72, s8, 0
    s_addc_u32 s73, s9, 0
    s_add_u32 s74, s6, 0
    s_addc_u32 s75, s7, 0
    s_add_u32 s76, s10, 0
    s_addc_u32 s77, s11, 0
    global_load_dwordx4 v[8:11], v1, s[72:73] nt
    global_load_dwordx4 v[28:31], v1, s[74:75] nt
    global_load_dwordx2 v[48:49], v2, s[76:77] nt
    s_load_dword s44, s[12:13], 0
    s_load_dwordx8 s[20:27], s[14:15], 0
    s_cmp_lt_u32 s48, 10
    s_cbranch_scc0 gem_part_kernel_nomload
    s_mul_i32 s50, s2, 10240
    v_add_u32 v110, s50, v1
    global_load_dwordx4 v[112:115], v110, s[4:5]
gem_part_kernel_nomload:
    s_add_u32 s72, s8, 16384
    s_addc_u32 s73, s9, 0
    s_add_u32 s74, s6, 16384
    s_addc_u32 s75, s7, 0
    s_add_u32 s76, s10, 8192
    s_addc_u32 s77, s11, 0
    global_load_dwordx4 v[12:15], v1, s[72:73] nt
    global_load_dwordx4 v[32:35], v1, s[74:75] nt
    global_load_dwordx2 v[50:51], v2, s[76:77] nt
    s_add_u32 s72, s8, 32768
    s_addc_u32 s73, s9, 0
    s_add_u32 s74, s6, 32768
    s_addc_u32 s75, s7, 0
    s_add_u32 s76, s10, 16384
    s_addc_u32 s77, s11, 0
    global_load_dwordx4 v[16:19], v1, s[72:73] nt
    global_load_dwordx4 v[36:39], v1, s[74:75] nt
    global_load_dwordx2 v[52:53], v2, s[76:77] nt
    s_mov_b32 s45, 429497
    s_mov_b32 s46, -10000
    s_mov_b32 s47, 268436
    s_mov_b32 s49, -16000
    s_barrier
    s_waitcnt vmcnt(6)
    s_waitcnt lgkmcnt(0)
    s_lshl_b32 s44, s44, 16
    v_mov_b32 v4, s44
    v_mul_f32 v4, 0.15915494, v4
    s_add_u32 s72, s8, 49152
    s_addc_u32 s73, s9, 0
    s_add_u32 s74, s6, 49152
    s_addc_u32 s75, s7, 0
    s_add_u32 s76, s10, 24576
    s_addc_u32 s77, s11, 0
    global_load_dwordx4 v[20:23], v1, s[72:73] nt
    global_load_dwordx4 v[40:43], v1, s[74:75] nt
    global_load_dwordx2 v[54:55], v2, s[76:77] nt
    v_mul_hi_u32 v116, v8, s45
    v_mul_hi_u32 v118, v28, s47
    v_mad_i32_i24 v117, v116, s46, v8
    v_mad_i32_i24 v28, v118, s49, v28
    v_lshlrev_b32 v118, 10, v118
    v_add_u32 v117, 1, v117
    v_lshlrev_b32 v28, 2, v28
    v_lshl_add_u32 v8, v116, 5, v118
    v_lshl_or_b32 v28, v117, 16, v28
    v_lshrrev_b32 v118, 15, v28
    v_and_b32 v118, 0x1c, v118
    v_add_u32 v8, v8, v118
    v_and_b32 v117, 0x10000, v28
    v_max_u32 v117, 1, v117
    ds_add_u32 v8, v117
    v_mul_hi_u32 v116, v9, s45
    v_mul_hi_u32 v118, v29, s47
    v_mad_i32_i24 v117, v116, s46, v9
    v_mad_i32_i24 v29, v118, s49, v29
    v_lshlrev_b32 v118, 10, v118
    v_add_u32 v117, 1, v117
    v_lshlrev_b32 v29, 2, v29
    v_lshl_add_u32 v9, v116, 5, v118
    v_lshl_or_b32 v29, v117, 16, v29
    v_lshrrev_b32 v118, 15, v29
    v_and_b32 v118, 0x1c, v118
    v_add_u32 v9, v9, v118
    v_and_b32 v118, 0x10000, v29
    v_max_u32 v118, 1, v118
    ds_add_u32 v9, v118
    v_mul_hi_u32 v116, v10, s45
    v_mul_hi_u32 v118, v30, s47
    v_mad_i32_i24 v117, v116, s46, v10
    v_mad_i32_i24 v30, v118, s49, v30
    v_lshlrev_b32 v118, 10, v118
    v_add_u32 v117, 1, v117
    v_lshlrev_b32 v30, 2, v30
    v_lshl_add_u32 v10, v116, 5, v118
    v_lshl_or_b32 v30, v117, 16, v30
    v_lshrrev_b32 v118, 15, v30
    v_and_b32 v118, 0x1c, v118
    v_add_u32 v10, v10, v118
    v_and_b32 v117, 0x10000, v30
    v_max_u32 v117, 1, v117
    ds_add_u32 v10, v117
    v_mul_hi_u32 v116, v11, s45
    v_mul_hi_u32 v118, v31, s47
    v_mad_i32_i24 v117, v116, s46, v11
    v_mad_i32_i24 v31, v118, s49, v31
    v_lshlrev_b32 v118, 10, v118
    v_add_u32 v117, 1, v117
    v_lshlrev_b32 v31, 2, v31
    v_lshl_add_u32 v11, v116, 5, v118
    v_lshl_or_b32 v31, v117, 16, v31
    v_lshrrev_b32 v118, 15, v31
    v_and_b32 v118, 0x1c, v118
    v_add_u32 v11, v11, v118
    v_and_b32 v118, 0x10000, v31
    v_max_u32 v118, 1, v118
    ds_add_u32 v11, v118
    v_lshlrev_b32 v119, 16, v48
    v_and_b32 v120, 0xffff0000, v48
    v_mul_f32 v119, v4, v119
    v_mul_f32 v120, v4, v120
    v_fract_f32 v119, v119
    v_fract_f32 v120, v120
    v_cos_f32 v119, v119
    v_cos_f32 v120, v120
    s_nop 0
    v_cvt_pk_bf16_f32 v48, v119, v120
    v_lshlrev_b32 v119, 16, v49
    v_and_b32 v120, 0xffff0000, v49
    v_mul_f32 v119, v4, v119
    v_mul_f32 v120, v4, v120
    v_fract_f32 v119, v119
    v_fract_f32 v120, v120
    v_cos_f32 v119, v119
    v_cos_f32 v120, v120
    s_nop 0
    v_cvt_pk_bf16_f32 v49, v119, v120
    s_cmp_lt_u32 s48, 10
    s_cbranch_scc0 gem_part_kernel_nomjob
    s_lshl_b32 s28, s20, 16
    s_and_b32 s29, s20, 0xffff0000
    s_lshl_b32 s30, s21, 16
    s_and_b32 s31, s21, 0xffff0000
    s_lshl_b32 s32, s22, 16
    s_and_b32 s33, s22, 0xffff0000
    s_lshl_b32 s34, s23, 16
    s_and_b32 s35, s23, 0xffff0000
    s_lshl_b32 s36, s24, 16
    s_and_b32 s37, s24, 0xffff0000
    s_lshl_b32 s38, s25, 16
    s_and_b32 s39, s25, 0xffff0000
    s_lshl_b32 s40, s26, 16
    s_and_b32 s41, s26, 0xffff0000
    s_lshl_b32 s42, s27, 16
    s_and_b32 s43, s27, 0xffff0000
    s_waitcnt vmcnt(9)
    v_mov_b32 v124, 0
    v_lshlrev_b32 v116, 16, v112
    v_and_b32 v117, 0xffff0000, v112
    v_lshlrev_b32 v118, 16, v113
    v_and_b32 v119, 0xffff0000, v113
    v_mul_f32 v120, s28, v116
    v_fma_f32 v120, v117, s32, v120
    v_fma_f32 v120, v118, s36, v120
    v_fma_f32 v120, v119, s40, v120
    v_mul_f32 v121, s29, v116
    v_fma_f32 v121, v117, s33, v121
    v_fma_f32 v121, v118, s37, v121
    v_fma_f32 v121, v119, s41, v121
    v_mul_f32 v122, s30, v116
    v_fma_f32 v122, v117, s34, v122
    v_fma_f32 v122, v118, s38, v122
    v_fma_f32 v122, v119, s42, v122
    v_mul_f32 v123, s31, v116
    v_fma_f32 v123, v117, s35, v123
    v_fma_f32 v123, v118, s39, v123
    v_fma_f32 v123, v119, s43, v123
    v_cvt_pk_bf16_f32 v126, v120, v121
    v_cvt_pk_bf16_f32 v108, v122, v123
    v_max_f32 v120, |v120|, |v121|
    v_max_f32 v122, |v122|, |v123|
    v_max3_f32 v124, v120, v122, v124
    v_lshlrev_b32 v116, 16, v114
    v_and_b32 v117, 0xffff0000, v114
    v_lshlrev_b32 v118, 16, v115
    v_and_b32 v119, 0xffff0000, v115
    v_mul_f32 v120, s28, v116
    v_fma_f32 v120, v117, s32, v120
    v_fma_f32 v120, v118, s36, v120
    v_fma_f32 v120, v119, s40, v120
    v_mul_f32 v121, s29, v116
    v_fma_f32 v121, v117, s33, v121
    v_fma_f32 v121, v118, s37, v121
    v_fma_f32 v121, v119, s41, v121
    v_mul_f32 v122, s30, v116
    v_fma_f32 v122, v117, s34, v122
    v_fma_f32 v122, v118, s38, v122
    v_fma_f32 v122, v119, s42, v122
    v_mul_f32 v123, s31, v116
    v_fma_f32 v123, v117, s35, v123
    v_fma_f32 v123, v118, s39, v123
    v_fma_f32 v123, v119, s43, v123
    v_cvt_pk_bf16_f32 v127, v120, v121
    v_cvt_pk_bf16_f32 v109, v122, v123
    v_max_f32 v120, |v120|, |v121|
    v_max_f32 v122, |v122|, |v123|
    v_max3_f32 v124, v120, v122, v124
    v_lshrrev_b32 v111, 1, v110
    s_add_u32 s54, s16, 68485120
    s_addc_u32 s55, s17, 0
    s_add_u32 s56, s16, 69795840
    s_addc_u32 s57, s17, 0
    global_store_dwordx2 v111, v[126:127], s[54:55]
    global_store_dwordx2 v111, v[108:109], s[56:57]
    s_nop 1
    v_max_u32_dpp v124, v124, v124 row_shr:1 row_mask:0xf bank_mask:0xf
    s_nop 1
    v_max_u32_dpp v124, v124, v124 row_shr:2 row_mask:0xf bank_mask:0xf
    s_nop 1
    v_max_u32_dpp v124, v124, v124 row_shr:4 row_mask:0xf bank_mask:0xf
    s_nop 1
    v_max_u32_dpp v124, v124, v124 row_shr:8 row_mask:0xf bank_mask:0xf
    s_nop 1
    v_max_u32_dpp v124, v124, v124 row_bcast:15 row_mask:0xa bank_mask:0xf
    s_nop 1
    v_max_u32_dpp v124, v124, v124 row_bcast:31 row_mask:0xc bank_mask:0xf
    s_nop 1
    s_nop 0
    v_readlane_b32 s58, v124, 63
    v_mov_b32 v116, 20544
    s_nop 0
    v_mov_b32 v117, s58
    ds_max_u32 v116, v117
gem_part_kernel_nomjob:
    s_waitcnt vmcnt(6)
    s_add_u32 s72, s8, 65536
    s_addc_u32 s73, s9, 0
    s_add_u32 s74, s6, 65536
    s_addc_u32 s75, s7, 0
    s_add_u32 s76, s10, 32768
    s_addc_u32 s77, s11, 0
    global_load_dwordx4 v[24:27], v1, s[72:73] nt
    global_load_dwordx4 v[44:47], v1, s[74:75] nt
    global_load_dwordx2 v[56:57], v2, s[76:77] nt
    v_mul_hi_u32 v116, v12, s45
    v_mul_hi_u32 v118, v32, s47
    v_mad_i32_i24 v117, v116, s46, v12
    v_mad_i32_i24 v32, v118, s49, v32
    v_lshlrev_b32 v118, 10, v118
    v_add_u32 v117, 1, v117
    v_lshlrev_b32 v32, 2, v32
    v_lshl_add_u32 v12, v116, 5, v118
    v_lshl_or_b32 v32, v117, 16, v32
    v_lshrrev_b32 v118, 15, v32
    v_and_b32 v118, 0x1c, v118
    v_add_u32 v12, v12, v118
    v_and_b32 v117, 0x10000, v32
    v_max_u32 v117, 1, v117
    ds_add_u32 v12, v117
    v_mul_hi_u32 v116, v13, s45
    v_mul_hi_u32 v118, v33, s47
    v_mad_i32_i24 v117, v116, s46, v13
    v_mad_i32_i24 v33, v118, s49, v33
    v_lshlrev_b32 v118, 10, v118
    v_add_u32 v117, 1, v117
    v_lshlrev_b32 v33, 2, v33
    v_lshl_add_u32 v13, v116, 5, v118
    v_lshl_or_b32 v33, v117, 16, v33
    v_lshrrev_b32 v118, 15, v33
    v_and_b32 v118, 0x1c, v118
    v_add_u32 v13, v13, v118
    v_and_b32 v118, 0x10000, v33
    v_max_u32 v118, 1, v118
    ds_add_u32 v13, v118
    v_mul_hi_u32 v116, v14, s45
    v_mul_hi_u32 v118, v34, s47
    v_mad_i32_i24 v117, v116, s46, v14
    v_mad_i32_i24 v34, v118, s49, v34
    v_lshlrev_b32 v118, 10, v118
    v_add_u32 v117, 1, v117
    v_lshlrev_b32 v34, 2, v34
    v_lshl_add_u32 v14, v116, 5, v118
    v_lshl_or_b32 v34, v117, 16, v34
    v_lshrrev_b32 v118, 15, v34
    v_and_b32 v118, 0x1c, v118
    v_add_u32 v14, v14, v118
    v_and_b32 v117, 0x10000, v34
    v_max_u32 v117, 1, v117
    ds_add_u32 v14, v117
    v_mul_hi_u32 v116, v15, s45
    v_mul_hi_u32 v118, v35, s47
    v_mad_i32_i24 v117, v116, s46, v15
    v_mad_i32_i24 v35, v118, s49, v35
    v_lshlrev_b32 v118, 10, v118
    v_add_u32 v117, 1, v117
    v_lshlrev_b32 v35, 2, v35
    v_lshl_add_u32 v15, v116, 5, v118
    v_lshl_or_b32 v35, v117, 16, v35
    v_lshrrev_b32 v118, 15, v35
    v_and_b32 v118, 0x1c, v118
    v_add_u32 v15, v15, v118
    v_and_b32 v118, 0x10000, v35
    v_max_u32 v118, 1, v118
    ds_add_u32 v15, v118
    v_lshlrev_b32 v119, 16, v50
    v_and_b32 v120, 0xffff0000, v50
    v_mul_f32 v119, v4, v119
    v_mul_f32 v120, v4, v120
    v_fract_f32 v119, v119
    v_fract_f32 v120, v120
    v_cos_f32 v119, v119
    v_cos_f32 v120, v120
    s_nop 0
    v_cvt_pk_bf16_f32 v50, v119, v120
    v_lshlrev_b32 v119, 16, v51
    v_and_b32 v120, 0xffff0000, v51
    v_mul_f32 v119, v4, v119
    v_mul_f32 v120, v4, v120
    v_fract_f32 v119, v119
    v_fract_f32 v120, v120
    v_cos_f32 v119, v119
    v_cos_f32 v120, v120
    s_nop 0
    v_cvt_pk_bf16_f32 v51, v119, v120
    s_waitcnt vmcnt(6)
    s_add_u32 s72, s8, 81920
    s_addc_u32 s73, s9, 0
    s_add_u32 s74, s6, 81920
    s_addc_u32 s75, s7, 0
    s_add_u32 s76, s10, 40960
    s_addc_u32 s77, s11, 0
    global_load_dwordx4 v[58:61], v1, s[72:73] nt
    global_load_dwordx4 v[78:81], v1, s[74:75] nt
    global_load_dwordx2 v[98:99], v2, s[76:77] nt
    v_mul_hi_u32 v116, v16, s45
    v_mul_hi_u32 v118, v36, s47
    v_mad_i32_i24 v117, v116, s46, v16
    v_mad_i32_i24 v36, v118, s49, v36
    v_lshlrev_b32 v118, 10, v118
    v_add_u32 v117, 1, v117
    v_lshlrev_b32 v36, 2, v36
    v_lshl_add_u32 v16, v116, 5, v118
    v_lshl_or_b32 v36, v117, 16, v36
    v_lshrrev_b32 v118, 15, v36
    v_and_b32 v118, 0x1c, v118
    v_add_u32 v16, v16, v118
    v_and_b32 v117, 0x10000, v36
    v_max_u32 v117, 1, v117
    ds_add_u32 v16, v117
    v_mul_hi_u32 v116, v17, s45
    v_mul_hi_u32 v118, v37, s47
    v_mad_i32_i24 v117, v116, s46, v17
    v_mad_i32_i24 v37, v118, s49, v37
    v_lshlrev_b32 v118, 10, v118
    v_add_u32 v117, 1, v117
    v_lshlrev_b32 v37, 2, v37
    v_lshl_add_u32 v17, v116, 5, v118
    v_lshl_or_b32 v37, v117, 16, v37
    v_lshrrev_b32 v118, 15, v37
    v_and_b32 v118, 0x1c, v118
    v_add_u32 v17, v17, v118
    v_and_b32 v118, 0x10000, v37
    v_max_u32 v118, 1, v118
    ds_add_u32 v17, v118
    v_mul_hi_u32 v116, v18, s45
    v_mul_hi_u32 v118, v38, s47
    v_mad_i32_i24 v117, v116, s46, v18
    v_mad_i32_i24 v38, v118, s49, v38
    v_lshlrev_b32 v118, 10, v118
    v_add_u32 v117, 1, v117
    v_lshlrev_b32 v38, 2, v38
    v_lshl_add_u32 v18, v116, 5, v118
    v_lshl_or_b32 v38, v117, 16, v38
    v_lshrrev_b32 v118, 15, v38
    v_and_b32 v118, 0x1c, v118
    v_add_u32 v18, v18, v118
    v_and_b32 v117, 0x10000, v38
    v_max_u32 v117, 1, v117
    ds_add_u32 v18, v117
    v_mul_hi_u32 v116, v19, s45
    v_mul_hi_u32 v118, v39, s47
    v_mad_i32_i24 v117, v116, s46, v19
    v_mad_i32_i24 v39, v118, s49, v39
    v_lshlrev_b32 v118, 10, v118
    v_add_u32 v117, 1, v117
    v_lshlrev_b32 v39, 2, v39
    v_lshl_add_u32 v19, v116, 5, v118
    v_lshl_or_b32 v39, v117, 16, v39
    v_lshrrev_b32 v118, 15, v39
    v_and_b32 v118, 0x1c, v118
    v_add_u32 v19, v19, v118
    v_and_b32 v118, 0x10000, v39
    v_max_u32 v118, 1, v118
    ds_add_u32 v19, v118
    v_lshlrev_b32 v119, 16, v52
    v_and_b32 v120, 0xffff0000, v52
    v_mul_f32 v119, v4, v119
    v_mul_f32 v120, v4, v120
    v_fract_f32 v119, v119
    v_fract_f32 v120, v120
    v_cos_f32 v119, v119
    v_cos_f32 v120, v120
    s_nop 0
    v_cvt_pk_bf16_f32 v52, v119, v120
    v_lshlrev_b32 v119, 16, v53
    v_and_b32 v120, 0xffff0000, v53
    v_mul_f32 v119, v4, v119
    v_mul_f32 v120, v4, v120
    v_fract_f32 v119, v119
    v_fract_f32 v120, v120
    v_cos_f32 v119, v119
    v_cos_f32 v120, v120
    s_nop 0
    v_cvt_pk_bf16_f32 v53, v119, v120
    s_waitcnt vmcnt(6)
    s_add_u32 s72, s8, 98304
    s_addc_u32 s73, s9, 0
    s_add_u32 s74, s6, 98304
    s_addc_u32 s75, s7, 0
    s_add_u32 s76, s10, 49152
    s_addc_u32 s77, s11, 0
    global_load_dwordx4 v[62:65], v1, s[72:73] nt
    global_load_dwordx4 v[82:85], v1, s[74:75] nt
    global_load_dwordx2 v[100:101], v2, s[76:77] nt
    v_mul_hi_u32 v116, v20, s45
    v_mul_hi_u32 v118, v40, s47
    v_mad_i32_i24 v117, v116, s46, v20
    v_mad_i32_i24 v40, v118, s49, v40
    v_lshlrev_b32 v118, 10, v118
    v_add_u32 v117, 1, v117
    v_lshlrev_b32 v40, 2, v40
    v_lshl_add_u32 v20, v116, 5, v118
    v_lshl_or_b32 v40, v117, 16, v40
    v_lshrrev_b32 v118, 15, v40
    v_and_b32 v118, 0x1c, v118
    v_add_u32 v20, v20, v118
    v_and_b32 v117, 0x10000, v40
    v_max_u32 v117, 1, v117
    ds_add_u32 v20, v117
    v_mul_hi_u32 v116, v21, s45
    v_mul_hi_u32 v118, v41, s47
    v_mad_i32_i24 v117, v116, s46, v21
    v_mad_i32_i24 v41, v118, s49, v41
    v_lshlrev_b32 v118, 10, v118
    v_add_u32 v117, 1, v117
    v_lshlrev_b32 v41, 2, v41
    v_lshl_add_u32 v21, v116, 5, v118
    v_lshl_or_b32 v41, v117, 16, v41
    v_lshrrev_b32 v118, 15, v41
    v_and_b32 v118, 0x1c, v118
    v_add_u32 v21, v21, v118
    v_and_b32 v118, 0x10000, v41
    v_max_u32 v118, 1, v118
    ds_add_u32 v21, v118
    v_mul_hi_u32 v116, v22, s45
    v_mul_hi_u32 v118, v42, s47
    v_mad_i32_i24 v117, v116, s46, v22
    v_mad_i32_i24 v42, v118, s49, v42
    v_lshlrev_b32 v118, 10, v118
    v_add_u32 v117, 1, v117
    v_lshlrev_b32 v42, 2, v42
    v_lshl_add_u32 v22, v116, 5, v118
    v_lshl_or_b32 v42, v117, 16, v42
    v_lshrrev_b32 v118, 15, v42
    v_and_b32 v118, 0x1c, v118
    v_add_u32 v22, v22, v118
    v_and_b32 v117, 0x10000, v42
    v_max_u32 v117, 1, v117
    ds_add_u32 v22, v117
    v_mul_hi_u32 v116, v23, s45
    v_mul_hi_u32 v118, v43, s47
    v_mad_i32_i24 v117, v116, s46, v23
    v_mad_i32_i24 v43, v118, s49, v43
    v_lshlrev_b32 v118, 10, v118
    v_add_u32 v117, 1, v117
    v_lshlrev_b32 v43, 2, v43
    v_lshl_add_u32 v23, v116, 5, v118
    v_lshl_or_b32 v43, v117, 16, v43
    v_lshrrev_b32 v118, 15, v43
    v_and_b32 v118, 0x1c, v118
    v_add_u32 v23, v23, v118
    v_and_b32 v118, 0x10000, v43
    v_max_u32 v118, 1, v118
    ds_add_u32 v23, v118
    v_lshlrev_b32 v119, 16, v54
    v_and_b32 v120, 0xffff0000, v54
    v_mul_f32 v119, v4, v119
    v_mul_f32 v120, v4, v120
    v_fract_f32 v119, v119
    v_fract_f32 v120, v120
    v_cos_f32 v119, v119
    v_cos_f32 v120, v120
    s_nop 0
    v_cvt_pk_bf16_f32 v54, v119, v120
    v_lshlrev_b32 v119, 16, v55
    v_and_b32 v120, 0xffff0000, v55
    v_mul_f32 v119, v4, v119
    v_mul_f32 v120, v4, v120
    v_fract_f32 v119, v119
    v_fract_f32 v120, v120
    v_cos_f32 v119, v119
    v_cos_f32 v120, v120
    s_nop 0
    v_cvt_pk_bf16_f32 v55, v119, v120
    s_waitcnt vmcnt(6)
    s_add_u32 s72, s8, 114688
    s_addc_u32 s73, s9, 0
    s_add_u32 s74, s6, 114688
    s_addc_u32 s75, s7, 0
    s_add_u32 s76, s10, 57344
    s_addc_u32 s77, s11, 0
    global_load_dwordx4 v[66:69], v1, s[72:73] nt
    global_load_dwordx4 v[86:89], v1, s[74:75] nt
    global_load_dwordx2 v[102:103], v2, s[76:77] nt
    v_mul_hi_u32 v116, v24, s45
    v_mul_hi_u32 v118, v44, s47
    v_mad_i32_i24 v117, v116, s46, v24
    v_mad_i32_i24 v44, v118, s49, v44
    v_lshlrev_b32 v118, 10, v118
    v_add_u32 v117, 1, v117
    v_lshlrev_b32 v44, 2, v44
    v_lshl_add_u32 v24, v116, 5, v118
    v_lshl_or_b32 v44, v117, 16, v44
    v_lshrrev_b32 v118, 15, v44
    v_and_b32 v118, 0x1c, v118
    v_add_u32 v24, v24, v118
    v_and_b32 v117, 0x10000, v44
    v_max_u32 v117, 1, v117
    ds_add_u32 v24, v117
    v_mul_hi_u32 v116, v25, s45
    v_mul_hi_u32 v118, v45, s47
    v_mad_i32_i24 v117, v116, s46, v25
    v_mad_i32_i24 v45, v118, s49, v45
    v_lshlrev_b32 v118, 10, v118
    v_add_u32 v117, 1, v117
    v_lshlrev_b32 v45, 2, v45
    v_lshl_add_u32 v25, v116, 5, v118
    v_lshl_or_b32 v45, v117, 16, v45
    v_lshrrev_b32 v118, 15, v45
    v_and_b32 v118, 0x1c, v118
    v_add_u32 v25, v25, v118
    v_and_b32 v118, 0x10000, v45
    v_max_u32 v118, 1, v118
    ds_add_u32 v25, v118
    v_mul_hi_u32 v116, v26, s45
    v_mul_hi_u32 v118, v46, s47
    v_mad_i32_i24 v117, v116, s46, v26
    v_mad_i32_i24 v46, v118, s49, v46
    v_lshlrev_b32 v118, 10, v118
    v_add_u32 v117, 1, v117
    v_lshlrev_b32 v46, 2, v46
    v_lshl_add_u32 v26, v116, 5, v118
    v_lshl_or_b32 v46, v117, 16, v46
    v_lshrrev_b32 v118, 15, v46
    v_and_b32 v118, 0x1c, v118
    v_add_u32 v26, v26, v118
    v_and_b32 v117, 0x10000, v46
    v_max_u32 v117, 1, v117
    ds_add_u32 v26, v117
    v_mul_hi_u32 v116, v27, s45
    v_mul_hi_u32 v118, v47, s47
    v_mad_i32_i24 v117, v116, s46, v27
    v_mad_i32_i24 v47, v118, s49, v47
    v_lshlrev_b32 v118, 10, v118
    v_add_u32 v117, 1, v117
    v_lshlrev_b32 v47, 2, v47
    v_lshl_add_u32 v27, v116, 5, v118
    v_lshl_or_b32 v47, v117, 16, v47
    v_lshrrev_b32 v118, 15, v47
    v_and_b32 v118, 0x1c, v118
    v_add_u32 v27, v27, v118
    v_and_b32 v118, 0x10000, v47
    v_max_u32 v118, 1, v118
    ds_add_u32 v27, v118
    v_lshlrev_b32 v119, 16, v56
    v_and_b32 v120, 0xffff0000, v56
    v_mul_f32 v119, v4, v119
    v_mul_f32 v120, v4, v120
    v_fract_f32 v119, v119
    v_fract_f32 v120, v120
    v_cos_f32 v119, v119
    v_cos_f32 v120, v120
    s_nop 0
    v_cvt_pk_bf16_f32 v56, v119, v120
    v_lshlrev_b32 v119, 16, v57
    v_and_b32 v120, 0xffff0000, v57
    v_mul_f32 v119, v4, v119
    v_mul_f32 v120, v4, v120
    v_fract_f32 v119, v119
    v_fract_f32 v120, v120
    v_cos_f32 v119, v119
    v_cos_f32 v120, v120
    s_nop 0
    v_cvt_pk_bf16_f32 v57, v119, v120
    s_waitcnt lgkmcnt(0)
    s_barrier
    v_mov_b32 v118, 0
    v_mov_b32 v119, 0
    v_mov_b32 v120, 0
    v_lshlrev_b32 v124, 5, v0
    s_cmp_lt_u32 s48, 10
    s_cbranch_scc0 gem_part_kernel_c0_s1done
    ds_read_b128 v[108:111], v124
    ds_read_b128 v[112:115], v124 offset:16
    s_waitcnt lgkmcnt(0)
    v_add3_u32 v116, v108, v109, v110
    v_add3_u32 v117, v111, v112, v113
    v_add3_u32 v116, v116, v114, v115
    v_add_u32 v116, v116, v117
    v_and_b32 v117, 0xffff, v116
    v_lshrrev_b32 v116, 16, v116
    v_add_u32 v118, v116, v117
    v_add_u32 v119, 3, v118
    v_and_b32 v119, -4, v119
    v_mov_b32 v120, v119
    s_nop 1
    v_add_u32_dpp v120, v120, v120 row_shr:1 row_mask:0xf bank_mask:0xf
    s_nop 1
    v_add_u32_dpp v120, v120, v120 row_shr:2 row_mask:0xf bank_mask:0xf
    s_nop 1
    v_add_u32_dpp v120, v120, v120 row_shr:4 row_mask:0xf bank_mask:0xf
    s_nop 1
    v_add_u32_dpp v120, v120, v120 row_shr:8 row_mask:0xf bank_mask:0xf
    s_nop 1
    v_add_u32_dpp v120, v120, v120 row_bcast:15 row_mask:0xa bank_mask:0xf
    s_nop 1
    v_add_u32_dpp v120, v120, v120 row_bcast:31 row_mask:0xc bank_mask:0xf
    s_nop 1
    v_readlane_b32 s58, v120, 63
    s_lshl_b32 s59, s48, 2
    s_add_u32 s59, s59, 20480
    v_mov_b32 v116, s59
    v_mov_b32 v117, s58
    ds_write_b32 v116, v117
    s_waitcnt lgkmcnt(0)
gem_part_kernel_c0_s1done:
    s_barrier
    v_and_b32 v116, 15, v0
    v_lshlrev_b32 v116, 2, v116
    ds_read_b32 v117, v116 offset:20480
    v_mov_b32 v125, 20544
    ds_read_b32 v126, v125
    s_waitcnt lgkmcnt(0)
    s_nop 1
    v_add_u32_dpp v117, v117, v117 row_shr:1 row_mask:0xf bank_mask:0xf
    s_nop 1
    v_add_u32_dpp v117, v117, v117 row_shr:2 row_mask:0xf bank_mask:0xf
    s_nop 1
    v_add_u32_dpp v117, v117, v117 row_shr:4 row_mask:0xf bank_mask:0xf
    s_nop 1
    v_add_u32_dpp v117, v117, v117 row_shr:8 row_mask:0xf bank_mask:0xf
    s_nop 1
    s_sub_u32 s59, s48, 1
    s_max_i32 s59, s59, 0
    v_readlane_b32 s60, v117, 15
    v_readlane_b32 s58, v117, s59
    s_cmp_eq_u32 s48, 0
    s_nop 1
    s_cselect_b32 s58, 0, s58
    s_cmp_lt_u32 s48, 10
    s_cbranch_scc0 gem_part_kernel_c0_s2done
    v_sub_u32 v121, v120, v119
    s_lshl_b32 s50, s2, 1
    v_add_u32 v121, s58, v121
    s_add_u32 s50, s50, 0
    s_and_b32 s61, s50, 15
    s_mul_i32 s50, s50, 2560
    s_add_u32 s50, s50, 67203072
    s_add_u32 s54, s16, s50
    s_addc_u32 s55, s17, 0
    v_add_u32 v116, v121, v119
    v_lshrrev_b32 v116, 2, v116
    v_lshrrev_b32 v117, 2, v121
    v_lshl_or_b32 v116, v116, 16, v117
    v_and_b32 v117, 31, v0
    v_mul_u32_u24 v117, 20, v117
    v_lshrrev_b32 v122, 5, v0
    v_add_lshl_u32 v117, v117, v122, 2
    global_store_dword v117, v116, s[54:55]
    v_mov_b32 v122, v121
    v_and_b32 v116, 0xffff, v108
    v_lshrrev_b32 v117, 16, v108
    v_add_u32 v116, v122, v116
    v_lshl_or_b32 v108, v116, 16, v122
    v_add_u32 v122, v116, v117
    v_and_b32 v116, 0xffff, v109
    v_lshrrev_b32 v117, 16, v109
    v_add_u32 v116, v122, v116
    v_lshl_or_b32 v109, v116, 16, v122
    v_add_u32 v122, v116, v117
    v_and_b32 v116, 0xffff, v110
    v_lshrrev_b32 v117, 16, v110
    v_add_u32 v116, v122, v116
    v_lshl_or_b32 v110, v116, 16, v122
    v_add_u32 v122, v116, v117
    v_and_b32 v116, 0xffff, v111
    v_lshrrev_b32 v117, 16, v111
    v_add_u32 v116, v122, v116
    v_lshl_or_b32 v111, v116, 16, v122
    v_add_u32 v122, v116, v117
    v_and_b32 v116, 0xffff, v112
    v_lshrrev_b32 v117, 16, v112
    v_add_u32 v116, v122, v116
    v_lshl_or_b32 v112, v116, 16, v122
    v_add_u32 v122, v116, v117
    v_and_b32 v116, 0xffff, v113
    v_lshrrev_b32 v117, 16, v113
    v_add_u32 v116, v122, v116
    v_lshl_or_b32 v113, v116, 16, v122
    v_add_u32 v122, v116, v117
    v_and_b32 v116, 0xffff, v114
    v_lshrrev_b32 v117, 16, v114
    v_add_u32 v116, v122, v116
    v_lshl_or_b32 v114, v116, 16, v122
    v_add_u32 v122, v116, v117
    v_and_b32 v116, 0xffff, v115
    v_lshrrev_b32 v117, 16, v115
    v_add_u32 v116, v122, v116
    v_lshl_or_b32 v115, v116, 16, v122
    v_add_u32 v122, v116, v117
    ds_write_b128 v124, v[108:111]
    ds_write_b128 v124, v[112:115] offset:16
    v_mul_u32_u24 v123, 15, v0
    v_add_u32 v123, s61, v123
    v_add_u32 v123, 1, v123
    v_lshlrev_b32 v123, 16, v123
    v_mov_b32 v127, 0
    v_add_u32 v116, 0, v118
    v_cmp_lt_u32 vcc, v116, v119
    v_and_b32 v117, 3, v116
    v_add_u32 v116, v116, v121
    v_mul_u32_u24 v116, 6, v116
    v_add_u32 v117, v117, v117
    v_sub_u32 v116, v116, v117
    v_sub_u32 v117, v116, v117
    s_and_saveexec_b64 s[52:53], vcc
    ds_write_b32 v116, v123 offset:20608
    ds_write_b16 v117, v127 offset:20624
    s_mov_b64 exec, s[52:53]
    v_add_u32 v116, 1, v118
    v_cmp_lt_u32 vcc, v116, v119
    v_and_b32 v117, 3, v116
    v_add_u32 v116, v116, v121
    v_mul_u32_u24 v116, 6, v116
    v_add_u32 v117, v117, v117
    v_sub_u32 v116, v116, v117
    v_sub_u32 v117, v116, v117
    s_and_saveexec_b64 s[52:53], vcc
    ds_write_b32 v116, v123 offset:20608
    ds_write_b16 v117, v127 offset:20624
    s_mov_b64 exec, s[52:53]
    v_add_u32 v116, 2, v118
    v_cmp_lt_u32 vcc, v116, v119
    v_and_b32 v117, 3, v116
    v_add_u32 v116, v116, v121
    v_mul_u32_u24 v116, 6, v116
    v_add_u32 v117, v117, v117
    v_sub_u32 v116, v116, v117
    v_sub_u32 v117, v116, v117
    s_and_saveexec_b64 s[52:53], vcc
    ds_write_b32 v116, v123 offset:20608
    ds_write_b16 v117, v127 offset:20624
    s_mov_b64 exec, s[52:53]
gem_part_kernel_c0_s2done:
    s_cmp_eq_u32 s48, 15
    s_cbranch_scc0 gem_part_kernel_c0_nomax
    s_lshl_b32 s50, s2, 2
    s_add_u32 s50, s50, 71106560
    s_add_u32 s54, s16, s50
    s_addc_u32 s55, s17, 0
    v_mov_b32 v108, 0
    s_mov_b64 exec, 1
    global_store_dword v108, v126, s[54:55]
    s_cmp_lt_u32 s2, 32
    s_cbranch_scc0 gem_part_kernel_c0_nocnt
    s_lshl_b32 s50, s2, 7
    s_add_u32 s50, s50, 81354752
    s_add_u32 s54, s16, s50
    s_addc_u32 s55, s17, 0
    global_store_dword v108, v108, s[54:55]
gem_part_kernel_c0_nocnt:
    s_mov_b64 exec, -1
gem_part_kernel_c0_nomax:
    s_add_u32 s72, s8, 131072
    s_addc_u32 s73, s9, 0
    s_add_u32 s74, s6, 131072
    s_addc_u32 s75, s7, 0
    s_add_u32 s76, s10, 65536
    s_addc_u32 s77, s11, 0
    global_load_dwordx4 v[70:73], v1, s[72:73] nt
    global_load_dwordx4 v[90:93], v1, s[74:75] nt
    global_load_dwordx2 v[104:105], v2, s[76:77] nt
    s_waitcnt lgkmcnt(0)
    s_barrier
    v_and_b32 v113, 0x10000, v28
    v_max_u32 v118, 1, v113
    ds_add_rtn_u32 v108, v8, v118
    v_lshrrev_b32 v113, 12, v113
    v_and_b32 v114, 0x10000, v29
    v_max_u32 v118, 1, v114
    ds_add_rtn_u32 v109, v9, v118
    v_lshrrev_b32 v114, 12, v114
    v_and_b32 v115, 0x10000, v30
    v_max_u32 v118, 1, v115
    ds_add_rtn_u32 v110, v10, v118
    v_lshrrev_b32 v115, 12, v115
    v_and_b32 v116, 0x10000, v31
    v_max_u32 v118, 1, v116
    ds_add_rtn_u32 v111, v11, v118
    v_lshrrev_b32 v116, 12, v116
    v_and_b32 v117, 0x10000, v32
    v_max_u32 v118, 1, v117
    ds_add_rtn_u32 v112, v12, v118
    v_lshrrev_b32 v117, 12, v117
    s_waitcnt lgkmcnt(4)
    v_lshrrev_b32 v108, v113, v108
    v_and_b32 v119, 3, v108
    v_and_b32 v108, 0xffff, v108
    v_add_u32 v119, v119, v119
    v_mul_u32_u24 v108, 6, v108
    v_sub_u32 v108, v108, v119
    v_sub_u32 v120, v108, v119
    ds_write_b32 v108, v28 offset:20608
    ds_write_b16 v120, v48 offset:20624
    s_waitcnt lgkmcnt(5)
    v_lshrrev_b32 v109, v114, v109
    v_and_b32 v119, 3, v109
    v_and_b32 v109, 0xffff, v109
    v_add_u32 v119, v119, v119
    v_mul_u32_u24 v109, 6, v109
    v_sub_u32 v109, v109, v119
    v_sub_u32 v120, v109, v119
    ds_write_b32 v109, v29 offset:20608
    ds_write_b16_d16_hi v120, v48 offset:20624
    s_waitcnt lgkmcnt(6)
    v_lshrrev_b32 v110, v115, v110
    v_and_b32 v119, 3, v110
    v_and_b32 v110, 0xffff, v110
    v_add_u32 v119, v119, v119
    v_mul_u32_u24 v110, 6, v110
    v_sub_u32 v110, v110, v119
    v_sub_u32 v120, v110, v119
    ds_write_b32 v110, v30 offset:20608
    ds_write_b16 v120, v49 offset:20624
    s_waitcnt lgkmcnt(7)
    v_lshrrev_b32 v111, v116, v111
    v_and_b32 v119, 3, v111
    v_and_b32 v111, 0xffff, v111
    v_add_u32 v119, v119, v119
    v_mul_u32_u24 v111, 6, v111
    v_sub_u32 v111, v111, v119
    v_sub_u32 v120, v111, v119
    ds_write_b32 v111, v31 offset:20608
    ds_write_b16_d16_hi v120, v49 offset:20624
    s_waitcnt lgkmcnt(8)
    v_lshrrev_b32 v112, v117, v112
    v_and_b32 v119, 3, v112
    v_and_b32 v112, 0xffff, v112
    v_add_u32 v119, v119, v119
    v_mul_u32_u24 v112, 6, v112
    v_sub_u32 v112, v112, v119
    v_sub_u32 v120, v112, v119
    ds_write_b32 v112, v32 offset:20608
    ds_write_b16 v120, v50 offset:20624
    s_waitcnt vmcnt(9)
    v_mul_hi_u32 v116, v58, s45
    v_mul_hi_u32 v118, v78, s47
    v_mad_i32_i24 v117, v116, s46, v58
    v_mad_i32_i24 v78, v118, s49, v78
    v_lshlrev_b32 v118, 10, v118
    v_add_u32 v117, 1, v117
    v_lshlrev_b32 v78, 2, v78
    v_lshl_add_u32 v58, v116, 5, v118
    v_lshl_or_b32 v78, v117, 16, v78
    v_lshrrev_b32 v118, 15, v78
    v_and_b32 v118, 0x1c, v118
    v_add_u32 v58, v58, v118
    v_mul_hi_u32 v116, v59, s45
    v_mul_hi_u32 v118, v79, s47
    v_mad_i32_i24 v117, v116, s46, v59
    v_mad_i32_i24 v79, v118, s49, v79
    v_lshlrev_b32 v118, 10, v118
    v_add_u32 v117, 1, v117
    v_lshlrev_b32 v79, 2, v79
    v_lshl_add_u32 v59, v116, 5, v118
    v_lshl_or_b32 v79, v117, 16, v79
    v_lshrrev_b32 v118, 15, v79
    v_and_b32 v118, 0x1c, v118
    v_add_u32 v59, v59, v118
    v_mul_hi_u32 v116, v60, s45
    v_mul_hi_u32 v118, v80, s47
    v_mad_i32_i24 v117, v116, s46, v60
    v_mad_i32_i24 v80, v118, s49, v80
    v_lshlrev_b32 v118, 10, v118
    v_add_u32 v117, 1, v117
    v_lshlrev_b32 v80, 2, v80
    v_lshl_add_u32 v60, v116, 5, v118
    v_lshl_or_b32 v80, v117, 16, v80
    v_lshrrev_b32 v118, 15, v80
    v_and_b32 v118, 0x1c, v118
    v_add_u32 v60, v60, v118
    v_mul_hi_u32 v116, v61, s45
    v_mul_hi_u32 v118, v81, s47
    v_mad_i32_i24 v117, v116, s46, v61
    v_mad_i32_i24 v81, v118, s49, v81
    v_lshlrev_b32 v118, 10, v118
    v_add_u32 v117, 1, v117
    v_lshlrev_b32 v81, 2, v81
    v_lshl_add_u32 v61, v116, 5, v118
    v_lshl_or_b32 v81, v117, 16, v81
    v_lshrrev_b32 v118, 15, v81
    v_and_b32 v118, 0x1c, v118
    v_add_u32 v61, v61, v118
    v_lshlrev_b32 v119, 16, v98
    v_and_b32 v120, 0xffff0000, v98
    v_mul_f32 v119, v4, v119
    v_mul_f32 v120, v4, v120
    v_fract_f32 v119, v119
    v_fract_f32 v120, v120
    v_cos_f32 v119, v119
    v_cos_f32 v120, v120
    s_nop 0
    v_cvt_pk_bf16_f32 v98, v119, v120
    v_lshlrev_b32 v119, 16, v99
    v_and_b32 v120, 0xffff0000, v99
    v_mul_f32 v119, v4, v119
    v_mul_f32 v120, v4, v120
    v_fract_f32 v119, v119
    v_fract_f32 v120, v120
    v_cos_f32 v119, v119
    v_cos_f32 v120, v120
    s_nop 0
    v_cvt_pk_bf16_f32 v99, v119, v120
    v_and_b32 v113, 0x10000, v33
    v_max_u32 v118, 1, v113
    ds_add_rtn_u32 v108, v13, v118
    v_lshrrev_b32 v113, 12, v113
    v_and_b32 v114, 0x10000, v34
    v_max_u32 v118, 1, v114
    ds_add_rtn_u32 v109, v14, v118
    v_lshrrev_b32 v114, 12, v114
    v_and_b32 v115, 0x10000, v35
    v_max_u32 v118, 1, v115
    ds_add_rtn_u32 v110, v15, v118
    v_lshrrev_b32 v115, 12, v115
    v_and_b32 v116, 0x10000, v36
    v_max_u32 v118, 1, v116
    ds_add_rtn_u32 v111, v16, v118
    v_lshrrev_b32 v116, 12, v116
    v_and_b32 v117, 0x10000, v37
    v_max_u32 v118, 1, v117
    ds_add_rtn_u32 v112, v17, v118
    v_lshrrev_b32 v117, 12, v117
    s_waitcnt lgkmcnt(4)
    v_lshrrev_b32 v108, v113, v108
    v_and_b32 v119, 3, v108
    v_and_b32 v108, 0xffff, v108
    v_add_u32 v119, v119, v119
    v_mul_u32_u24 v108, 6, v108
    v_sub_u32 v108, v108, v119
    v_sub_u32 v120, v108, v119
    ds_write_b32 v108, v33 offset:20608
    ds_write_b16_d16_hi v120, v50 offset:20624
    s_waitcnt lgkmcnt(5)
    v_lshrrev_b32 v109, v114, v109
    v_and_b32 v119, 3, v109
    v_and_b32 v109, 0xffff, v109
    v_add_u32 v119, v119, v119
    v_mul_u32_u24 v109, 6, v109
    v_sub_u32 v109, v109, v119
    v_sub_u32 v120, v109, v119
    ds_write_b32 v109, v34 offset:20608
    ds_write_b16 v120, v51 offset:20624
    s_waitcnt lgkmcnt(6)
    v_lshrrev_b32 v110, v115, v110
    v_and_b32 v119, 3, v110
    v_and_b32 v110, 0xffff, v110
    v_add_u32 v119, v119, v119
    v_mul_u32_u24 v110, 6, v110
    v_sub_u32 v110, v110, v119
    v_sub_u32 v120, v110, v119
    ds_write_b32 v110, v35 offset:20608
    ds_write_b16_d16_hi v120, v51 offset:20624
    s_waitcnt lgkmcnt(7)
    v_lshrrev_b32 v111, v116, v111
    v_and_b32 v119, 3, v111
    v_and_b32 v111, 0xffff, v111
    v_add_u32 v119, v119, v119
    v_mul_u32_u24 v111, 6, v111
    v_sub_u32 v111, v111, v119
    v_sub_u32 v120, v111, v119
    ds_write_b32 v111, v36 offset:20608
    ds_write_b16 v120, v52 offset:20624
    s_waitcnt lgkmcnt(8)
    v_lshrrev_b32 v112, v117, v112
    v_and_b32 v119, 3, v112
    v_and_b32 v112, 0xffff, v112
    v_add_u32 v119, v119, v119
    v_mul_u32_u24 v112, 6, v112
    v_sub_u32 v112, v112, v119
    v_sub_u32 v120, v112, v119
    ds_write_b32 v112, v37 offset:20608
    ds_write_b16_d16_hi v120, v52 offset:20624
    s_add_u32 s72, s8, 147456
    s_addc_u32 s73, s9, 0
    s_add_u32 s74, s6, 147456
    s_addc_u32 s75, s7, 0
    s_add_u32 s76, s10, 73728
    s_addc_u32 s77, s11, 0
    global_load_dwordx4 v[74:77], v1, s[72:73] nt
    global_load_dwordx4 v[94:97], v1, s[74:75] nt
    global_load_dwordx2 v[106:107], v2, s[76:77] nt
    s_waitcnt vmcnt(9)
    v_mul_hi_u32 v116, v62, s45
    v_mul_hi_u32 v118, v82, s47
    v_mad_i32_i24 v117, v116, s46, v62
    v_mad_i32_i24 v82, v118, s49, v82
    v_lshlrev_b32 v118, 10, v118
    v_add_u32 v117, 1, v117
    v_lshlrev_b32 v82, 2, v82
    v_lshl_add_u32 v62, v116, 5, v118
    v_lshl_or_b32 v82, v117, 16, v82
    v_lshrrev_b32 v118, 15, v82
    v_and_b32 v118, 0x1c, v118
    v_add_u32 v62, v62, v118
    v_mul_hi_u32 v116, v63, s45
    v_mul_hi_u32 v118, v83, s47
    v_mad_i32_i24 v117, v116, s46, v63
    v_mad_i32_i24 v83, v118, s49, v83
    v_lshlrev_b32 v118, 10, v118
    v_add_u32 v117, 1, v117
    v_lshlrev_b32 v83, 2, v83
    v_lshl_add_u32 v63, v116, 5, v118
    v_lshl_or_b32 v83, v117, 16, v83
    v_lshrrev_b32 v118, 15, v83
    v_and_b32 v118, 0x1c, v118
    v_add_u32 v63, v63, v118
    v_mul_hi_u32 v116, v64, s45
    v_mul_hi_u32 v118, v84, s47
    v_mad_i32_i24 v117, v116, s46, v64
    v_mad_i32_i24 v84, v118, s49, v84
    v_lshlrev_b32 v118, 10, v118
    v_add_u32 v117, 1, v117
    v_lshlrev_b32 v84, 2, v84
    v_lshl_add_u32 v64, v116, 5, v118
    v_lshl_or_b32 v84, v117, 16, v84
    v_lshrrev_b32 v118, 15, v84
    v_and_b32 v118, 0x1c, v118
    v_add_u32 v64, v64, v118
    v_mul_hi_u32 v116, v65, s45
    v_mul_hi_u32 v118, v85, s47
    v_mad_i32_i24 v117, v116, s46, v65
    v_mad_i32_i24 v85, v118, s49, v85
    v_lshlrev_b32 v118, 10, v118
    v_add_u32 v117, 1, v117
    v_lshlrev_b32 v85, 2, v85
    v_lshl_add_u32 v65, v116, 5, v118
    v_lshl_or_b32 v85, v117, 16, v85
    v_lshrrev_b32 v118, 15, v85
    v_and_b32 v118, 0x1c, v118
    v_add_u32 v65, v65, v118
    v_lshlrev_b32 v119, 16, v100
    v_and_b32 v120, 0xffff0000, v100
    v_mul_f32 v119, v4, v119
    v_mul_f32 v120, v4, v120
    v_fract_f32 v119, v119
    v_fract_f32 v120, v120
    v_cos_f32 v119, v119
    v_cos_f32 v120, v120
    s_nop 0
    v_cvt_pk_bf16_f32 v100, v119, v120
    v_lshlrev_b32 v119, 16, v101
    v_and_b32 v120, 0xffff0000, v101
    v_mul_f32 v119, v4, v119
    v_mul_f32 v120, v4, v120
    v_fract_f32 v119, v119
    v_fract_f32 v120, v120
    v_cos_f32 v119, v119
    v_cos_f32 v120, v120
    s_nop 0
    v_cvt_pk_bf16_f32 v101, v119, v120
    v_and_b32 v113, 0x10000, v38
    v_max_u32 v118, 1, v113
    ds_add_rtn_u32 v108, v18, v118
    v_lshrrev_b32 v113, 12, v113
    v_and_b32 v114, 0x10000, v39
    v_max_u32 v118, 1, v114
    ds_add_rtn_u32 v109, v19, v118
    v_lshrrev_b32 v114, 12, v114
    v_and_b32 v115, 0x10000, v40
    v_max_u32 v118, 1, v115
    ds_add_rtn_u32 v110, v20, v118
    v_lshrrev_b32 v115, 12, v115
    v_and_b32 v116, 0x10000, v41
    v_max_u32 v118, 1, v116
    ds_add_rtn_u32 v111, v21, v118
    v_lshrrev_b32 v116, 12, v116
    v_and_b32 v117, 0x10000, v42
    v_max_u32 v118, 1, v117
    ds_add_rtn_u32 v112, v22, v118
    v_lshrrev_b32 v117, 12, v117
    s_waitcnt lgkmcnt(4)
    v_lshrrev_b32 v108, v113, v108
    v_and_b32 v119, 3, v108
    v_and_b32 v108, 0xffff, v108
    v_add_u32 v119, v119, v119
    v_mul_u32_u24 v108, 6, v108
    v_sub_u32 v108, v108, v119
    v_sub_u32 v120, v108, v119
    ds_write_b32 v108, v38 offset:20608
    ds_write_b16 v120, v53 offset:20624
    s_waitcnt lgkmcnt(5)
    v_lshrrev_b32 v109, v114, v109
    v_and_b32 v119, 3, v109
    v_and_b32 v109, 0xffff, v109
    v_add_u32 v119, v119, v119
    v_mul_u32_u24 v109, 6, v109
    v_sub_u32 v109, v109, v119
    v_sub_u32 v120, v109, v119
    ds_write_b32 v109, v39 offset:20608
    ds_write_b16_d16_hi v120, v53 offset:20624
    s_waitcnt lgkmcnt(6)
    v_lshrrev_b32 v110, v115, v110
    v_and_b32 v119, 3, v110
    v_and_b32 v110, 0xffff, v110
    v_add_u32 v119, v119, v119
    v_mul_u32_u24 v110, 6, v110
    v_sub_u32 v110, v110, v119
    v_sub_u32 v120, v110, v119
    ds_write_b32 v110, v40 offset:20608
    ds_write_b16 v120, v54 offset:20624
    s_waitcnt lgkmcnt(7)
    v_lshrrev_b32 v111, v116, v111
    v_and_b32 v119, 3, v111
    v_and_b32 v111, 0xffff, v111
    v_add_u32 v119, v119, v119
    v_mul_u32_u24 v111, 6, v111
    v_sub_u32 v111, v111, v119
    v_sub_u32 v120, v111, v119
    ds_write_b32 v111, v41 offset:20608
    ds_write_b16_d16_hi v120, v54 offset:20624
    s_waitcnt lgkmcnt(8)
    v_lshrrev_b32 v112, v117, v112
    v_and_b32 v119, 3, v112
    v_and_b32 v112, 0xffff, v112
    v_add_u32 v119, v119, v119
    v_mul_u32_u24 v112, 6, v112
    v_sub_u32 v112, v112, v119
    v_sub_u32 v120, v112, v119
    ds_write_b32 v112, v42 offset:20608
    ds_write_b16 v120, v55 offset:20624
    s_waitcnt vmcnt(6)
    v_mul_hi_u32 v116, v66, s45
    v_mul_hi_u32 v118, v86, s47
    v_mad_i32_i24 v117, v116, s46, v66
    v_mad_i32_i24 v86, v118, s49, v86
    v_lshlrev_b32 v118, 10, v118
    v_add_u32 v117, 1, v117
    v_lshlrev_b32 v86, 2, v86
    v_lshl_add_u32 v66, v116, 5, v118
    v_lshl_or_b32 v86, v117, 16, v86
    v_lshrrev_b32 v118, 15, v86
    v_and_b32 v118, 0x1c, v118
    v_add_u32 v66, v66, v118
    v_mul_hi_u32 v116, v67, s45
    v_mul_hi_u32 v118, v87, s47
    v_mad_i32_i24 v117, v116, s46, v67
    v_mad_i32_i24 v87, v118, s49, v87
    v_lshlrev_b32 v118, 10, v118
    v_add_u32 v117, 1, v117
    v_lshlrev_b32 v87, 2, v87
    v_lshl_add_u32 v67, v116, 5, v118
    v_lshl_or_b32 v87, v117, 16, v87
    v_lshrrev_b32 v118, 15, v87
    v_and_b32 v118, 0x1c, v118
    v_add_u32 v67, v67, v118
    v_mul_hi_u32 v116, v68, s45
    v_mul_hi_u32 v118, v88, s47
    v_mad_i32_i24 v117, v116, s46, v68
    v_mad_i32_i24 v88, v118, s49, v88
    v_lshlrev_b32 v118, 10, v118
    v_add_u32 v117, 1, v117
    v_lshlrev_b32 v88, 2, v88
    v_lshl_add_u32 v68, v116, 5, v118
    v_lshl_or_b32 v88, v117, 16, v88
    v_lshrrev_b32 v118, 15, v88
    v_and_b32 v118, 0x1c, v118
    v_add_u32 v68, v68, v118
    v_mul_hi_u32 v116, v69, s45
    v_mul_hi_u32 v118, v89, s47
    v_mad_i32_i24 v117, v116, s46, v69
    v_mad_i32_i24 v89, v118, s49, v89
    v_lshlrev_b32 v118, 10, v118
    v_add_u32 v117, 1, v117
    v_lshlrev_b32 v89, 2, v89
    v_lshl_add_u32 v69, v116, 5, v118
    v_lshl_or_b32 v89, v117, 16, v89
    v_lshrrev_b32 v118, 15, v89
    v_and_b32 v118, 0x1c, v118
    v_add_u32 v69, v69, v118
    v_lshlrev_b32 v119, 16, v102
    v_and_b32 v120, 0xffff0000, v102
    v_mul_f32 v119, v4, v119
    v_mul_f32 v120, v4, v120
    v_fract_f32 v119, v119
    v_fract_f32 v120, v120
    v_cos_f32 v119, v119
    v_cos_f32 v120, v120
    s_nop 0
    v_cvt_pk_bf16_f32 v102, v119, v120
    v_lshlrev_b32 v119, 16, v103
    v_and_b32 v120, 0xffff0000, v103
    v_mul_f32 v119, v4, v119
    v_mul_f32 v120, v4, v120
    v_fract_f32 v119, v119
    v_fract_f32 v120, v120
    v_cos_f32 v119, v119
    v_cos_f32 v120, v120
    s_nop 0
    v_cvt_pk_bf16_f32 v103, v119, v120
    v_and_b32 v113, 0x10000, v43
    v_max_u32 v118, 1, v113
    ds_add_rtn_u32 v108, v23, v118
    v_lshrrev_b32 v113, 12, v113
    v_and_b32 v114, 0x10000, v44
    v_max_u32 v118, 1, v114
    ds_add_rtn_u32 v109, v24, v118
    v_lshrrev_b32 v114, 12, v114
    v_and_b32 v115, 0x10000, v45
    v_max_u32 v118, 1, v115
    ds_add_rtn_u32 v110, v25, v118
    v_lshrrev_b32 v115, 12, v115
    v_and_b32 v116, 0x10000, v46
    v_max_u32 v118, 1, v116
    ds_add_rtn_u32 v111, v26, v118
    v_lshrrev_b32 v116, 12, v116
    v_and_b32 v117, 0x10000, v47
    v_max_u32 v118, 1, v117
    ds_add_rtn_u32 v112, v27, v118
    v_lshrrev_b32 v117, 12, v117
    s_waitcnt lgkmcnt(4)
    v_lshrrev_b32 v108, v113, v108
    v_and_b32 v119, 3, v108
    v_and_b32 v108, 0xffff, v108
    v_add_u32 v119, v119, v119
    v_mul_u32_u24 v108, 6, v108
    v_sub_u32 v108, v108, v119
    v_sub_u32 v120, v108, v119
    ds_write_b32 v108, v43 offset:20608
    ds_write_b16_d16_hi v120, v55 offset:20624
    s_waitcnt lgkmcnt(5)
    v_lshrrev_b32 v109, v114, v109
    v_and_b32 v119, 3, v109
    v_and_b32 v109, 0xffff, v109
    v_add_u32 v119, v119, v119
    v_mul_u32_u24 v109, 6, v109
    v_sub_u32 v109, v109, v119
    v_sub_u32 v120, v109, v119
    ds_write_b32 v109, v44 offset:20608
    ds_write_b16 v120, v56 offset:20624
    s_waitcnt lgkmcnt(6)
    v_lshrrev_b32 v110, v115, v110
    v_and_b32 v119, 3, v110
    v_and_b32 v110, 0xffff, v110
    v_add_u32 v119, v119, v119
    v_mul_u32_u24 v110, 6, v110
    v_sub_u32 v110, v110, v119
    v_sub_u32 v120, v110, v119
    ds_write_b32 v110, v45 offset:20608
    ds_write_b16_d16_hi v120, v56 offset:20624
    s_waitcnt lgkmcnt(7)
    v_lshrrev_b32 v111, v116, v111
    v_and_b32 v119, 3, v111
    v_and_b32 v111, 0xffff, v111
    v_add_u32 v119, v119, v119
    v_mul_u32_u24 v111, 6, v111
    v_sub_u32 v111, v111, v119
    v_sub_u32 v120, v111, v119
    ds_write_b32 v111, v46 offset:20608
    ds_write_b16 v120, v57 offset:20624
    s_waitcnt lgkmcnt(8)
    v_lshrrev_b32 v112, v117, v112
    v_and_b32 v119, 3, v112
    v_and_b32 v112, 0xffff, v112
    v_add_u32 v119, v119, v119
    v_mul_u32_u24 v112, 6, v112
    v_sub_u32 v112, v112, v119
    v_sub_u32 v120, v112, v119
    ds_write_b32 v112, v47 offset:20608
    ds_write_b16_d16_hi v120, v57 offset:20624
    s_waitcnt lgkmcnt(0)
    s_barrier
    v_mov_b32 v114, 0
    v_mov_b32 v115, 0
    v_mov_b32 v116, 0
    v_mov_b32 v117, 0
    ds_write_b128 v1, v[114:117]
    v_cmp_gt_u32 vcc, 256, v0
    s_and_saveexec_b64 s[52:53], vcc
    ds_write_b128 v1, v[114:117] offset:16384
    s_mov_b64 exec, s[52:53]
    s_lshl_b32 s50, s2, 1
    s_add_u32 s50, s50, 0
    s_mul_i32 s50, s50, 134400
    s_add_u32 s50, s50, 0
    s_add_u32 s54, s16, s50
    s_addc_u32 s55, s17, 0
    s_mul_i32 s59, s60, 6
    s_add_u32 s59, s59, 15
    s_lshr_b32 s59, s59, 4
    v_add_u32 v108, 20608, v1
    v_add_u32 v109, 65536, v108
    v_add_u32 v110, 7168, v0
    v_add_u32 v111, 8192, v0
    v_cmp_gt_u32 s[62:63], s59, v110
    v_cmp_gt_u32 s[64:65], s59, v111
    v_add_u32 v112, 131072, v108
    s_mov_b64 exec, s[62:63]
    ds_read_b128 v[36:39], v109 offset:49152
    s_mov_b64 exec, s[64:65]
    ds_read_b128 v[40:43], v112
    s_mov_b64 exec, -1
    ds_read_b128 v[8:11], v108 offset:0
    ds_read_b128 v[12:15], v108 offset:16384
    ds_read_b128 v[16:19], v108 offset:32768
    ds_read_b128 v[20:23], v108 offset:49152
    ds_read_b128 v[24:27], v109 offset:0
    ds_read_b128 v[28:31], v109 offset:16384
    ds_read_b128 v[32:35], v109 offset:32768
    v_mov_b32 v113, v1
    s_waitcnt lgkmcnt(0)
    s_barrier
    s_mov_b64 s[66:67], s[62:63]
    s_mov_b64 s[68:69], s[64:65]
    s_mov_b64 s[78:79], s[54:55]
    v_mov_b32 v6, v1
    v_and_b32 v117, 0x10000, v78
    v_max_u32 v117, 1, v117
    ds_add_u32 v58, v117
    v_and_b32 v118, 0x10000, v79
    v_max_u32 v118, 1, v118
    ds_add_u32 v59, v118
    v_and_b32 v117, 0x10000, v80
    v_max_u32 v117, 1, v117
    ds_add_u32 v60, v117
    v_and_b32 v118, 0x10000, v81
    v_max_u32 v118, 1, v118
    ds_add_u32 v61, v118
    global_store_dwordx4 v6, v[8:11], s[78:79] sc1
    v_add_u32 v6, 16384, v6
    v_and_b32 v117, 0x10000, v82
    v_max_u32 v117, 1, v117
    ds_add_u32 v62, v117
    v_and_b32 v118, 0x10000, v83
    v_max_u32 v118, 1, v118
    ds_add_u32 v63, v118
    v_and_b32 v117, 0x10000, v84
    v_max_u32 v117, 1, v117
    ds_add_u32 v64, v117
    v_and_b32 v118, 0x10000, v85
    v_max_u32 v118, 1, v118
    ds_add_u32 v65, v118
    global_store_dwordx4 v6, v[12:15], s[78:79] sc1
    v_add_u32 v6, 16384, v6
    v_and_b32 v117, 0x10000, v86
    v_max_u32 v117, 1, v117
    ds_add_u32 v66, v117
    v_and_b32 v118, 0x10000, v87
    v_max_u32 v118, 1, v118
    ds_add_u32 v67, v118
    v_and_b32 v117, 0x10000, v88
    v_max_u32 v117, 1, v117
    ds_add_u32 v68, v117
    v_and_b32 v118, 0x10000, v89
    v_max_u32 v118, 1, v118
    ds_add_u32 v69, v118
    global_store_dwordx4 v6, v[16:19], s[78:79] sc1
    v_add_u32 v6, 16384, v6
    s_waitcnt vmcnt(6)
    v_mul_hi_u32 v116, v70, s45
    v_mul_hi_u32 v118, v90, s47
    v_mad_i32_i24 v117, v116, s46, v70
    v_mad_i32_i24 v90, v118, s49, v90
    v_lshlrev_b32 v118, 10, v118
    v_add_u32 v117, 1, v117
    v_lshlrev_b32 v90, 2, v90
    v_lshl_add_u32 v70, v116, 5, v118
    v_lshl_or_b32 v90, v117, 16, v90
    v_lshrrev_b32 v118, 15, v90
    v_and_b32 v118, 0x1c, v118
    v_add_u32 v70, v70, v118
    v_and_b32 v117, 0x10000, v90
    v_max_u32 v117, 1, v117
    ds_add_u32 v70, v117
    v_mul_hi_u32 v116, v71, s45
    v_mul_hi_u32 v118, v91, s47
    v_mad_i32_i24 v117, v116, s46, v71
    v_mad_i32_i24 v91, v118, s49, v91
    v_lshlrev_b32 v118, 10, v118
    v_add_u32 v117, 1, v117
    v_lshlrev_b32 v91, 2, v91
    v_lshl_add_u32 v71, v116, 5, v118
    v_lshl_or_b32 v91, v117, 16, v91
    v_lshrrev_b32 v118, 15, v91
    v_and_b32 v118, 0x1c, v118
    v_add_u32 v71, v71, v118
    v_and_b32 v118, 0x10000, v91
    v_max_u32 v118, 1, v118
    ds_add_u32 v71, v118
    v_mul_hi_u32 v116, v72, s45
    v_mul_hi_u32 v118, v92, s47
    v_mad_i32_i24 v117, v116, s46, v72
    v_mad_i32_i24 v92, v118, s49, v92
    v_lshlrev_b32 v118, 10, v118
    v_add_u32 v117, 1, v117
    v_lshlrev_b32 v92, 2, v92
    v_lshl_add_u32 v72, v116, 5, v118
    v_lshl_or_b32 v92, v117, 16, v92
    v_lshrrev_b32 v118, 15, v92
    v_and_b32 v118, 0x1c, v118
    v_add_u32 v72, v72, v118
    v_and_b32 v117, 0x10000, v92
    v_max_u32 v117, 1, v117
    ds_add_u32 v72, v117
    v_mul_hi_u32 v116, v73, s45
    v_mul_hi_u32 v118, v93, s47
    v_mad_i32_i24 v117, v116, s46, v73
    v_mad_i32_i24 v93, v118, s49, v93
    v_lshlrev_b32 v118, 10, v118
    v_add_u32 v117, 1, v117
    v_lshlrev_b32 v93, 2, v93
    v_lshl_add_u32 v73, v116, 5, v118
    v_lshl_or_b32 v93, v117, 16, v93
    v_lshrrev_b32 v118, 15, v93
    v_and_b32 v118, 0x1c, v118
    v_add_u32 v73, v73, v118
    v_and_b32 v118, 0x10000, v93
    v_max_u32 v118, 1, v118
    ds_add_u32 v73, v118
    v_lshlrev_b32 v119, 16, v104
    v_and_b32 v120, 0xffff0000, v104
    v_mul_f32 v119, v4, v119
    v_mul_f32 v120, v4, v120
    v_fract_f32 v119, v119
    v_fract_f32 v120, v120
    v_cos_f32 v119, v119
    v_cos_f32 v120, v120
    s_nop 0
    v_cvt_pk_bf16_f32 v104, v119, v120
    v_lshlrev_b32 v119, 16, v105
    v_and_b32 v120, 0xffff0000, v105
    v_mul_f32 v119, v4, v119
    v_mul_f32 v120, v4, v120
    v_fract_f32 v119, v119
    v_fract_f32 v120, v120
    v_cos_f32 v119, v119
    v_cos_f32 v120, v120
    s_nop 0
    v_cvt_pk_bf16_f32 v105, v119, v120
    global_store_dwordx4 v6, v[20:23], s[78:79] sc1
    v_add_u32 v6, 16384, v6
    s_waitcnt vmcnt(4)
    v_mul_hi_u32 v116, v74, s45
    v_mul_hi_u32 v118, v94, s47
    v_mad_i32_i24 v117, v116, s46, v74
    v_mad_i32_i24 v94, v118, s49, v94
    v_lshlrev_b32 v118, 10, v118
    v_add_u32 v117, 1, v117
    v_lshlrev_b32 v94, 2, v94
    v_lshl_add_u32 v74, v116, 5, v118
    v_lshl_or_b32 v94, v117, 16, v94
    v_lshrrev_b32 v118, 15, v94
    v_and_b32 v118, 0x1c, v118
    v_add_u32 v74, v74, v118
    v_and_b32 v117, 0x10000, v94
    v_max_u32 v117, 1, v117
    ds_add_u32 v74, v117
    v_mul_hi_u32 v116, v75, s45
    v_mul_hi_u32 v118, v95, s47
    v_mad_i32_i24 v117, v116, s46, v75
    v_mad_i32_i24 v95, v118, s49, v95
    v_lshlrev_b32 v118, 10, v118
    v_add_u32 v117, 1, v117
    v_lshlrev_b32 v95, 2, v95
    v_lshl_add_u32 v75, v116, 5, v118
    v_lshl_or_b32 v95, v117, 16, v95
    v_lshrrev_b32 v118, 15, v95
    v_and_b32 v118, 0x1c, v118
    v_add_u32 v75, v75, v118
    v_and_b32 v118, 0x10000, v95
    v_max_u32 v118, 1, v118
    ds_add_u32 v75, v118
    v_mul_hi_u32 v116, v76, s45
    v_mul_hi_u32 v118, v96, s47
    v_mad_i32_i24 v117, v116, s46, v76
    v_mad_i32_i24 v96, v118, s49, v96
    v_lshlrev_b32 v118, 10, v118
    v_add_u32 v117, 1, v117
    v_lshlrev_b32 v96, 2, v96
    v_lshl_add_u32 v76, v116, 5, v118
    v_lshl_or_b32 v96, v117, 16, v96
    v_lshrrev_b32 v118, 15, v96
    v_and_b32 v118, 0x1c, v118
    v_add_u32 v76, v76, v118
    v_and_b32 v117, 0x10000, v96
    v_max_u32 v117, 1, v117
    ds_add_u32 v76, v117
    v_mul_hi_u32 v116, v77, s45
    v_mul_hi_u32 v118, v97, s47
    v_mad_i32_i24 v117, v116, s46, v77
    v_mad_i32_i24 v97, v118, s49, v97
    v_lshlrev_b32 v118, 10, v118
    v_add_u32 v117, 1, v117
    v_lshlrev_b32 v97, 2, v97
    v_lshl_add_u32 v77, v116, 5, v118
    v_lshl_or_b32 v97, v117, 16, v97
    v_lshrrev_b32 v118, 15, v97
    v_and_b32 v118, 0x1c, v118
    v_add_u32 v77, v77, v118
    v_and_b32 v118, 0x10000, v97
    v_max_u32 v118, 1, v118
    ds_add_u32 v77, v118
    v_lshlrev_b32 v119, 16, v106
    v_and_b32 v120, 0xffff0000, v106
    v_mul_f32 v119, v4, v119
    v_mul_f32 v120, v4, v120
    v_fract_f32 v119, v119
    v_fract_f32 v120, v120
    v_cos_f32 v119, v119
    v_cos_f32 v120, v120
    s_nop 0
    v_cvt_pk_bf16_f32 v106, v119, v120
    v_lshlrev_b32 v119, 16, v107
    v_and_b32 v120, 0xffff0000, v107
    v_mul_f32 v119, v4, v119
    v_mul_f32 v120, v4, v120
    v_fract_f32 v119, v119
    v_fract_f32 v120, v120
    v_cos_f32 v119, v119
    v_cos_f32 v120, v120
    s_nop 0
    v_cvt_pk_bf16_f32 v107, v119, v120
    global_store_dwordx4 v6, v[24:27], s[78:79] sc1
    v_add_u32 v6, 16384, v6
    s_waitcnt lgkmcnt(0)
    s_barrier
    v_mov_b32 v118, 0
    v_mov_b32 v119, 0
    v_mov_b32 v120, 0
    v_lshlrev_b32 v124, 5, v0
    s_cmp_lt_u32 s48, 10
    s_cbranch_scc0 gem_part_kernel_c1_s1done
    ds_read_b128 v[108:111], v124
    ds_read_b128 v[112:115], v124 offset:16
    s_waitcnt lgkmcnt(0)
    v_add3_u32 v116, v108, v109, v110
    v_add3_u32 v117, v111, v112, v113
    v_add3_u32 v116, v116, v114, v115
    v_add_u32 v116, v116, v117
    v_and_b32 v117, 0xffff, v116
    v_lshrrev_b32 v116, 16, v116
    v_add_u32 v118, v116, v117
    v_add_u32 v119, 3, v118
    v_and_b32 v119, -4, v119
    v_mov_b32 v120, v119
    s_nop 1
    v_add_u32_dpp v120, v120, v120 row_shr:1 row_mask:0xf bank_mask:0xf
    s_nop 1
    v_add_u32_dpp v120, v120, v120 row_shr:2 row_mask:0xf bank_mask:0xf
    s_nop 1
    v_add_u32_dpp v120, v120, v120 row_shr:4 row_mask:0xf bank_mask:0xf
    s_nop 1
    v_add_u32_dpp v120, v120, v120 row_shr:8 row_mask:0xf bank_mask:0xf
    s_nop 1
    v_add_u32_dpp v120, v120, v120 row_bcast:15 row_mask:0xa bank_mask:0xf
    s_nop 1
    v_add_u32_dpp v120, v120, v120 row_bcast:31 row_mask:0xc bank_mask:0xf
    s_nop 1
    v_readlane_b32 s58, v120, 63
    s_lshl_b32 s59, s48, 2
    s_add_u32 s59, s59, 20480
    v_mov_b32 v116, s59
    v_mov_b32 v117, s58
    ds_write_b32 v116, v117
    s_waitcnt lgkmcnt(0)
gem_part_kernel_c1_s1done:
    s_barrier
    v_and_b32 v116, 15, v0
    v_lshlrev_b32 v116, 2, v116
    ds_read_b32 v117, v116 offset:20480
    s_waitcnt lgkmcnt(0)
    s_nop 1
    v_add_u32_dpp v117, v117, v117 row_shr:1 row_mask:0xf bank_mask:0xf
    s_nop 1
    v_add_u32_dpp v117, v117, v117 row_shr:2 row_mask:0xf bank_mask:0xf
    s_nop 1
    v_add_u32_dpp v117, v117, v117 row_shr:4 row_mask:0xf bank_mask:0xf
    s_nop 1
    v_add_u32_dpp v117, v117, v117 row_shr:8 row_mask:0xf bank_mask:0xf
    s_nop 1
    s_sub_u32 s59, s48, 1
    s_max_i32 s59, s59, 0
    v_readlane_b32 s60, v117, 15
    v_readlane_b32 s58, v117, s59
    s_cmp_eq_u32 s48, 0
    s_nop 1
    s_cselect_b32 s58, 0, s58
    s_cmp_lt_u32 s48, 10
    s_cbranch_scc0 gem_part_kernel_c1_s2done
    v_sub_u32 v121, v120, v119
    s_lshl_b32 s50, s2, 1
    v_add_u32 v121, s58, v121
    s_add_u32 s50, s50, 1
    s_and_b32 s61, s50, 15
    s_mul_i32 s50, s50, 2560
    s_add_u32 s50, s50, 67203072
    s_add_u32 s54, s16, s50
    s_addc_u32 s55, s17, 0
    v_add_u32 v116, v121, v119
    v_lshrrev_b32 v116, 2, v116
    v_lshrrev_b32 v117, 2, v121
    v_lshl_or_b32 v116, v116, 16, v117
    v_and_b32 v117, 31, v0
    v_mul_u32_u24 v117, 20, v117
    v_lshrrev_b32 v122, 5, v0
    v_add_lshl_u32 v117, v117, v122, 2
    global_store_dword v117, v116, s[54:55]
    v_mov_b32 v122, v121
    v_and_b32 v116, 0xffff, v108
    v_lshrrev_b32 v117, 16, v108
    v_add_u32 v116, v122, v116
    v_lshl_or_b32 v108, v116, 16, v122
    v_add_u32 v122, v116, v117
    v_and_b32 v116, 0xffff, v109
    v_lshrrev_b32 v117, 16, v109
    v_add_u32 v116, v122, v116
    v_lshl_or_b32 v109, v116, 16, v122
    v_add_u32 v122, v116, v117
    v_and_b32 v116, 0xffff, v110
    v_lshrrev_b32 v117, 16, v110
    v_add_u32 v116, v122, v116
    v_lshl_or_b32 v110, v116, 16, v122
    v_add_u32 v122, v116, v117
    v_and_b32 v116, 0xffff, v111
    v_lshrrev_b32 v117, 16, v111
    v_add_u32 v116, v122, v116
    v_lshl_or_b32 v111, v116, 16, v122
    v_add_u32 v122, v116, v117
    v_and_b32 v116, 0xffff, v112
    v_lshrrev_b32 v117, 16, v112
    v_add_u32 v116, v122, v116
    v_lshl_or_b32 v112, v116, 16, v122
    v_add_u32 v122, v116, v117
    v_and_b32 v116, 0xffff, v113
    v_lshrrev_b32 v117, 16, v113
    v_add_u32 v116, v122, v116
    v_lshl_or_b32 v113, v116, 16, v122
    v_add_u32 v122, v116, v117
    v_and_b32 v116, 0xffff, v114
    v_lshrrev_b32 v117, 16, v114
    v_add_u32 v116, v122, v116
    v_lshl_or_b32 v114, v116, 16, v122
    v_add_u32 v122, v116, v117
    v_and_b32 v116, 0xffff, v115
    v_lshrrev_b32 v117, 16, v115
    v_add_u32 v116, v122, v116
    v_lshl_or_b32 v115, v116, 16, v122
    v_add_u32 v122, v116, v117
    ds_write_b128 v124, v[108:111]
    ds_write_b128 v124, v[112:115] offset:16
    v_mul_u32_u24 v123, 15, v0
    v_add_u32 v123, s61, v123
    v_add_u32 v123, 1, v123
    v_lshlrev_b32 v123, 16, v123
    v_mov_b32 v127, 0
    v_add_u32 v116, 0, v118
    v_cmp_lt_u32 vcc, v116, v119
    v_and_b32 v117, 3, v116
    v_add_u32 v116, v116, v121
    v_mul_u32_u24 v116, 6, v116
    v_add_u32 v117, v117, v117
    v_sub_u32 v116, v116, v117
    v_sub_u32 v117, v116, v117
    s_and_saveexec_b64 s[52:53], vcc
    ds_write_b32 v116, v123 offset:20608
    ds_write_b16 v117, v127 offset:20624
    s_mov_b64 exec, s[52:53]
    v_add_u32 v116, 1, v118
    v_cmp_lt_u32 vcc, v116, v119
    v_and_b32 v117, 3, v116
    v_add_u32 v116, v116, v121
    v_mul_u32_u24 v116, 6, v116
    v_add_u32 v117, v117, v117
    v_sub_u32 v116, v116, v117
    v_sub_u32 v117, v116, v117
    s_and_saveexec_b64 s[52:53], vcc
    ds_write_b32 v116, v123 offset:20608
    ds_write_b16 v117, v127 offset:20624
    s_mov_b64 exec, s[52:53]
    v_add_u32 v116, 2, v118
    v_cmp_lt_u32 vcc, v116, v119
    v_and_b32 v117, 3, v116
    v_add_u32 v116, v116, v121
    v_mul_u32_u24 v116, 6, v116
    v_add_u32 v117, v117, v117
    v_sub_u32 v116, v116, v117
    v_sub_u32 v117, v116, v117
    s_and_saveexec_b64 s[52:53], vcc
    ds_write_b32 v116, v123 offset:20608
    ds_write_b16 v117, v127 offset:20624
    s_mov_b64 exec, s[52:53]
gem_part_kernel_c1_s2done:
    s_waitcnt lgkmcnt(0)
    s_barrier
    v_and_b32 v113, 0x10000, v78
    v_max_u32 v118, 1, v113
    ds_add_rtn_u32 v108, v58, v118
    v_lshrrev_b32 v113, 12, v113
    v_and_b32 v114, 0x10000, v79
    v_max_u32 v118, 1, v114
    ds_add_rtn_u32 v109, v59, v118
    v_lshrrev_b32 v114, 12, v114
    v_and_b32 v115, 0x10000, v80
    v_max_u32 v118, 1, v115
    ds_add_rtn_u32 v110, v60, v118
    v_lshrrev_b32 v115, 12, v115
    v_and_b32 v116, 0x10000, v81
    v_max_u32 v118, 1, v116
    ds_add_rtn_u32 v111, v61, v118
    v_lshrrev_b32 v116, 12, v116
    v_and_b32 v117, 0x10000, v82
    v_max_u32 v118, 1, v117
    ds_add_rtn_u32 v112, v62, v118
    v_lshrrev_b32 v117, 12, v117
    s_waitcnt lgkmcnt(4)
    v_lshrrev_b32 v108, v113, v108
    v_and_b32 v119, 3, v108
    v_and_b32 v108, 0xffff, v108
    v_add_u32 v119, v119, v119
    v_mul_u32_u24 v108, 6, v108
    v_sub_u32 v108, v108, v119
    v_sub_u32 v120, v108, v119
    ds_write_b32 v108, v78 offset:20608
    ds_write_b16 v120, v98 offset:20624
    s_waitcnt lgkmcnt(5)
    v_lshrrev_b32 v109, v114, v109
    v_and_b32 v119, 3, v109
    v_and_b32 v109, 0xffff, v109
    v_add_u32 v119, v119, v119
    v_mul_u32_u24 v109, 6, v109
    v_sub_u32 v109, v109, v119
    v_sub_u32 v120, v109, v119
    ds_write_b32 v109, v79 offset:20608
    ds_write_b16_d16_hi v120, v98 offset:20624
    s_waitcnt lgkmcnt(6)
    v_lshrrev_b32 v110, v115, v110
    v_and_b32 v119, 3, v110
    v_and_b32 v110, 0xffff, v110
    v_add_u32 v119, v119, v119
    v_mul_u32_u24 v110, 6, v110
    v_sub_u32 v110, v110, v119
    v_sub_u32 v120, v110, v119
    ds_write_b32 v110, v80 offset:20608
    ds_write_b16 v120, v99 offset:20624
    s_waitcnt lgkmcnt(7)
    v_lshrrev_b32 v111, v116, v111
    v_and_b32 v119, 3, v111
    v_and_b32 v111, 0xffff, v111
    v_add_u32 v119, v119, v119
    v_mul_u32_u24 v111, 6, v111
    v_sub_u32 v111, v111, v119
    v_sub_u32 v120, v111, v119
    ds_write_b32 v111, v81 offset:20608
    ds_write_b16_d16_hi v120, v99 offset:20624
    s_waitcnt lgkmcnt(8)
    v_lshrrev_b32 v112, v117, v112
    v_and_b32 v119, 3, v112
    v_and_b32 v112, 0xffff, v112
    v_add_u32 v119, v119, v119
    v_mul_u32_u24 v112, 6, v112
    v_sub_u32 v112, v112, v119
    v_sub_u32 v120, v112, v119
    ds_write_b32 v112, v82 offset:20608
    ds_write_b16 v120, v100 offset:20624
    global_store_dwordx4 v6, v[28:31], s[78:79] sc1
    v_add_u32 v6, 16384, v6
    v_and_b32 v113, 0x10000, v83
    v_max_u32 v118, 1, v113
    ds_add_rtn_u32 v108, v63, v118
    v_lshrrev_b32 v113, 12, v113
    v_and_b32 v114, 0x10000, v84
    v_max_u32 v118, 1, v114
    ds_add_rtn_u32 v109, v64, v118
    v_lshrrev_b32 v114, 12, v114
    v_and_b32 v115, 0x10000, v85
    v_max_u32 v118, 1, v115
    ds_add_rtn_u32 v110, v65, v118
    v_lshrrev_b32 v115, 12, v115
    v_and_b32 v116, 0x10000, v86
    v_max_u32 v118, 1, v116
    ds_add_rtn_u32 v111, v66, v118
    v_lshrrev_b32 v116, 12, v116
    v_and_b32 v117, 0x10000, v87
    v_max_u32 v118, 1, v117
    ds_add_rtn_u32 v112, v67, v118
    v_lshrrev_b32 v117, 12, v117
    s_waitcnt lgkmcnt(4)
    v_lshrrev_b32 v108, v113, v108
    v_and_b32 v119, 3, v108
    v_and_b32 v108, 0xffff, v108
    v_add_u32 v119, v119, v119
    v_mul_u32_u24 v108, 6, v108
    v_sub_u32 v108, v108, v119
    v_sub_u32 v120, v108, v119
    ds_write_b32 v108, v83 offset:20608
    ds_write_b16_d16_hi v120, v100 offset:20624
    s_waitcnt lgkmcnt(5)
    v_lshrrev_b32 v109, v114, v109
    v_and_b32 v119, 3, v109
    v_and_b32 v109, 0xffff, v109
    v_add_u32 v119, v119, v119
    v_mul_u32_u24 v109, 6, v109
    v_sub_u32 v109, v109, v119
    v_sub_u32 v120, v109, v119
    ds_write_b32 v109, v84 offset:20608
    ds_write_b16 v120, v101 offset:20624
    s_waitcnt lgkmcnt(6)
    v_lshrrev_b32 v110, v115, v110
    v_and_b32 v119, 3, v110
    v_and_b32 v110, 0xffff, v110
    v_add_u32 v119, v119, v119
    v_mul_u32_u24 v110, 6, v110
    v_sub_u32 v110, v110, v119
    v_sub_u32 v120, v110, v119
    ds_write_b32 v110, v85 offset:20608
    ds_write_b16_d16_hi v120, v101 offset:20624
    s_waitcnt lgkmcnt(7)
    v_lshrrev_b32 v111, v116, v111
    v_and_b32 v119, 3, v111
    v_and_b32 v111, 0xffff, v111
    v_add_u32 v119, v119, v119
    v_mul_u32_u24 v111, 6, v111
    v_sub_u32 v111, v111, v119
    v_sub_u32 v120, v111, v119
    ds_write_b32 v111, v86 offset:20608
    ds_write_b16 v120, v102 offset:20624
    s_waitcnt lgkmcnt(8)
    v_lshrrev_b32 v112, v117, v112
    v_and_b32 v119, 3, v112
    v_and_b32 v112, 0xffff, v112
    v_add_u32 v119, v119, v119
    v_mul_u32_u24 v112, 6, v112
    v_sub_u32 v112, v112, v119
    v_sub_u32 v120, v112, v119
    ds_write_b32 v112, v87 offset:20608
    ds_write_b16_d16_hi v120, v102 offset:20624
    global_store_dwordx4 v6, v[32:35], s[78:79] sc1
    v_add_u32 v6, 16384, v6
    v_and_b32 v113, 0x10000, v88
    v_max_u32 v118, 1, v113
    ds_add_rtn_u32 v108, v68, v118
    v_lshrrev_b32 v113, 12, v113
    v_and_b32 v114, 0x10000, v89
    v_max_u32 v118, 1, v114
    ds_add_rtn_u32 v109, v69, v118
    v_lshrrev_b32 v114, 12, v114
    v_and_b32 v115, 0x10000, v90
    v_max_u32 v118, 1, v115
    ds_add_rtn_u32 v110, v70, v118
    v_lshrrev_b32 v115, 12, v115
    v_and_b32 v116, 0x10000, v91
    v_max_u32 v118, 1, v116
    ds_add_rtn_u32 v111, v71, v118
    v_lshrrev_b32 v116, 12, v116
    v_and_b32 v117, 0x10000, v92
    v_max_u32 v118, 1, v117
    ds_add_rtn_u32 v112, v72, v118
    v_lshrrev_b32 v117, 12, v117
    s_waitcnt lgkmcnt(4)
    v_lshrrev_b32 v108, v113, v108
    v_and_b32 v119, 3, v108
    v_and_b32 v108, 0xffff, v108
    v_add_u32 v119, v119, v119
    v_mul_u32_u24 v108, 6, v108
    v_sub_u32 v108, v108, v119
    v_sub_u32 v120, v108, v119
    ds_write_b32 v108, v88 offset:20608
    ds_write_b16 v120, v103 offset:20624
    s_waitcnt lgkmcnt(5)
    v_lshrrev_b32 v109, v114, v109
    v_and_b32 v119, 3, v109
    v_and_b32 v109, 0xffff, v109
    v_add_u32 v119, v119, v119
    v_mul_u32_u24 v109, 6, v109
    v_sub_u32 v109, v109, v119
    v_sub_u32 v120, v109, v119
    ds_write_b32 v109, v89 offset:20608
    ds_write_b16_d16_hi v120, v103 offset:20624
    s_waitcnt lgkmcnt(6)
    v_lshrrev_b32 v110, v115, v110
    v_and_b32 v119, 3, v110
    v_and_b32 v110, 0xffff, v110
    v_add_u32 v119, v119, v119
    v_mul_u32_u24 v110, 6, v110
    v_sub_u32 v110, v110, v119
    v_sub_u32 v120, v110, v119
    ds_write_b32 v110, v90 offset:20608
    ds_write_b16 v120, v104 offset:20624
    s_waitcnt lgkmcnt(7)
    v_lshrrev_b32 v111, v116, v111
    v_and_b32 v119, 3, v111
    v_and_b32 v111, 0xffff, v111
    v_add_u32 v119, v119, v119
    v_mul_u32_u24 v111, 6, v111
    v_sub_u32 v111, v111, v119
    v_sub_u32 v120, v111, v119
    ds_write_b32 v111, v91 offset:20608
    ds_write_b16_d16_hi v120, v104 offset:20624
    s_waitcnt lgkmcnt(8)
    v_lshrrev_b32 v112, v117, v112
    v_and_b32 v119, 3, v112
    v_and_b32 v112, 0xffff, v112
    v_add_u32 v119, v119, v119
    v_mul_u32_u24 v112, 6, v112
    v_sub_u32 v112, v112, v119
    v_sub_u32 v120, v112, v119
    ds_write_b32 v112, v92 offset:20608
    ds_write_b16 v120, v105 offset:20624
    s_mov_b64 exec, s[66:67]
    s_cbranch_execz L_df_8
    global_store_dwordx4 v6, v[36:39], s[78:79] sc1
L_df_8:
    s_mov_b64 exec, -1
    v_add_u32 v6, 16384, v6
    v_and_b32 v113, 0x10000, v93
    v_max_u32 v118, 1, v113
    ds_add_rtn_u32 v108, v73, v118
    v_lshrrev_b32 v113, 12, v113
    v_and_b32 v114, 0x10000, v94
    v_max_u32 v118, 1, v114
    ds_add_rtn_u32 v109, v74, v118
    v_lshrrev_b32 v114, 12, v114
    v_and_b32 v115, 0x10000, v95
    v_max_u32 v118, 1, v115
    ds_add_rtn_u32 v110, v75, v118
    v_lshrrev_b32 v115, 12, v115
    v_and_b32 v116, 0x10000, v96
    v_max_u32 v118, 1, v116
    ds_add_rtn_u32 v111, v76, v118
    v_lshrrev_b32 v116, 12, v116
    v_and_b32 v117, 0x10000, v97
    v_max_u32 v118, 1, v117
    ds_add_rtn_u32 v112, v77, v118
    v_lshrrev_b32 v117, 12, v117
    s_waitcnt lgkmcnt(4)
    v_lshrrev_b32 v108, v113, v108
    v_and_b32 v119, 3, v108
    v_and_b32 v108, 0xffff, v108
    v_add_u32 v119, v119, v119
    v_mul_u32_u24 v108, 6, v108
    v_sub_u32 v108, v108, v119
    v_sub_u32 v120, v108, v119
    ds_write_b32 v108, v93 offset:20608
    ds_write_b16_d16_hi v120, v105 offset:20624
    s_waitcnt lgkmcnt(5)
    v_lshrrev_b32 v109, v114, v109
    v_and_b32 v119, 3, v109
    v_and_b32 v109, 0xffff, v109
    v_add_u32 v119, v119, v119
    v_mul_u32_u24 v109, 6, v109
    v_sub_u32 v109, v109, v119
    v_sub_u32 v120, v109, v119
    ds_write_b32 v109, v94 offset:20608
    ds_write_b16 v120, v106 offset:20624
    s_waitcnt lgkmcnt(6)
    v_lshrrev_b32 v110, v115, v110
    v_and_b32 v119, 3, v110
    v_and_b32 v110, 0xffff, v110
    v_add_u32 v119, v119, v119
    v_mul_u32_u24 v110, 6, v110
    v_sub_u32 v110, v110, v119
    v_sub_u32 v120, v110, v119
    ds_write_b32 v110, v95 offset:20608
    ds_write_b16_d16_hi v120, v106 offset:20624
    s_waitcnt lgkmcnt(7)
    v_lshrrev_b32 v111, v116, v111
    v_and_b32 v119, 3, v111
    v_and_b32 v111, 0xffff, v111
    v_add_u32 v119, v119, v119
    v_mul_u32_u24 v111, 6, v111
    v_sub_u32 v111, v111, v119
    v_sub_u32 v120, v111, v119
    ds_write_b32 v111, v96 offset:20608
    ds_write_b16 v120, v107 offset:20624
    s_waitcnt lgkmcnt(8)
    v_lshrrev_b32 v112, v117, v112
    v_and_b32 v119, 3, v112
    v_and_b32 v112, 0xffff, v112
    v_add_u32 v119, v119, v119
    v_mul_u32_u24 v112, 6, v112
    v_sub_u32 v112, v112, v119
    v_sub_u32 v120, v112, v119
    ds_write_b32 v112, v97 offset:20608
    ds_write_b16_d16_hi v120, v107 offset:20624
    s_mov_b64 exec, s[68:69]
    s_cbranch_execz L_df_9
    global_store_dwordx4 v6, v[40:43], s[78:79] sc1
L_df_9:
    s_mov_b64 exec, -1
    v_add_u32 v6, 16384, v6
    s_waitcnt lgkmcnt(0)
    s_barrier
    s_lshl_b32 s50, s2, 1
    s_add_u32 s50, s50, 1
    s_mul_i32 s50, s50, 134400
    s_add_u32 s50, s50, 0
    s_add_u32 s54, s16, s50
    s_addc_u32 s55, s17, 0
    s_mul_i32 s59, s60, 6
    s_add_u32 s59, s59, 15
    s_lshr_b32 s59, s59, 4
    v_add_u32 v108, 20608, v1
    v_add_u32 v109, 65536, v108
    v_add_u32 v110, 7168, v0
    v_add_u32 v111, 8192, v0
    v_cmp_gt_u32 s[62:63], s59, v110
    v_cmp_gt_u32 s[64:65], s59, v111
    v_add_u32 v112, 131072, v108
    s_mov_b64 exec, s[62:63]
    ds_read_b128 v[86:89], v109 offset:49152
    s_mov_b64 exec, s[64:65]
    ds_read_b128 v[90:93], v112
    s_mov_b64 exec, -1
    ds_read_b128 v[58:61], v108 offset:0
    ds_read_b128 v[62:65], v108 offset:16384
    ds_read_b128 v[66:69], v108 offset:32768
    ds_read_b128 v[70:73], v108 offset:49152
    ds_read_b128 v[74:77], v109 offset:0
    ds_read_b128 v[78:81], v109 offset:16384
    ds_read_b128 v[82:85], v109 offset:32768
    v_mov_b32 v113, v1
    s_waitcnt lgkmcnt(6)
    global_store_dwordx4 v113, v[58:61], s[54:55] sc1
    v_add_u32 v113, 16384, v113
    s_waitcnt lgkmcnt(5)
    global_store_dwordx4 v113, v[62:65], s[54:55] sc1
    v_add_u32 v113, 16384, v113
    s_waitcnt lgkmcnt(4)
    global_store_dwordx4 v113, v[66:69], s[54:55] sc1
    v_add_u32 v113, 16384, v113
    s_waitcnt lgkmcnt(3)
    global_store_dwordx4 v113, v[70:73], s[54:55] sc1
    v_add_u32 v113, 16384, v113
    s_waitcnt lgkmcnt(2)
    global_store_dwordx4 v113, v[74:77], s[54:55] sc1
    v_add_u32 v113, 16384, v113
    s_waitcnt lgkmcnt(1)
    global_store_dwordx4 v113, v[78:81], s[54:55] sc1
    v_add_u32 v113, 16384, v113
    s_waitcnt lgkmcnt(0)
    global_store_dwordx4 v113, v[82:85], s[54:55] sc1
    v_add_u32 v113, 16384, v113
    s_mov_b64 exec, s[62:63]
    s_cbranch_execz gem_part_kernel_c1_cdone
    global_store_dwordx4 v113, v[86:89], s[54:55] sc1
    v_add_u32 v113, 16384, v113
    s_mov_b64 exec, s[64:65]
    s_cbranch_execz gem_part_kernel_c1_cdone
    global_store_dwordx4 v113, v[90:93], s[54:55] sc1
gem_part_kernel_c1_cdone:
    s_mov_b64 exec, -1
gem_part_kernel_end:
    s_endpgm
.globl gem_acc_kernel
.p2align 8
.type gem_acc_kernel,@function
gem_acc_kernel:
    s_cmp_ge_u32 s2, 256
    s_cbranch_scc1 gem_acc_kernel_end
    s_mov_b32 s14, 0
gem_acc_kernel_redo:
    s_load_dwordx2 s[4:5], s[0:1], 104
    s_load_dwordx2 s[86:87], s[0:1], 0
    s_load_dwordx2 s[88:89], s[0:1], 24
    s_load_dwordx2 s[90:91], s[0:1], 40
    s_load_dwordx4 s[92:95], s[0:1], 56
    s_load_dwordx4 s[96:99], s[0:1], 80
    s_and_b32 s48, s2, 7
    s_lshr_b32 s49, s2, 3
    s_lshr_b32 s6, s48, 1
    s_and_b32 s48, s48, 1
    s_lshl_b32 s48, s48, 4
    s_lshr_b32 s7, s49, 1
    s_add_u32 s7, s7, s48
    s_and_b32 s8, s49, 1
    v_lshrrev_b32 v13, 6, v0
    v_and_b32 v15, 63, v0
    v_readfirstlane_b32 s9, v13
    v_mul_u32_u24 v1, 24, v15
    v_lshlrev_b32 v12, 4, v15
    v_lshlrev_b32 v13, 5, v13
    v_add_u32 v16, v13, v15
    s_mov_b32 s48, 134400
    v_mul_lo_u32 v2, v16, s48
    v_cmp_gt_u32 vcc, 32, v15
    s_mov_b32 s48, 500
    v_cmp_gt_u32 s[50:51], s48, v16
    s_and_b64 s[68:69], vcc, s[50:51]
    s_cmp_eq_u32 s9, 15
    s_cbranch_scc0 gem_acc_kernel_nopf
    s_cmp_lt_u32 s2, 16
    s_cbranch_scc0 gem_acc_kernel_nopf
    s_getpc_b64 s[60:61]
gem_acc_kernel_pf_pc:
    s_add_u32 s60, s60, gem_acc_kernel_pfbase-gem_acc_kernel_pf_pc
    s_addc_u32 s61, s61, 0
    v_lshlrev_b32 v21, 7, v15
    v_min_u32 v21, gem_acc_kernel_end-gem_acc_kernel_pfbase, v21
    global_load_dword v14, v21, s[60:61]
    v_add_u32 v21, 8192, v21
    v_min_u32 v21, gem_acc_kernel_end-gem_acc_kernel_pfbase, v21
    global_load_dword v14, v21, s[60:61]
    v_add_u32 v21, 8192, v21
    v_min_u32 v21, gem_acc_kernel_end-gem_acc_kernel_pfbase, v21
    global_load_dword v14, v21, s[60:61]
gem_acc_kernel_nopf:
gem_acc_kernel_pfbase:
    s_mov_b32 s16, 0xB4C00000
    s_mov_b32 s17, 0xB4BFFFFF
    s_waitcnt lgkmcnt(0)
    s_add_u32 s10, s4, 0
    s_addc_u32 s11, s5, 0
    s_mul_i32 s48, s8, 1310720
    s_mul_i32 s49, s6, 320000
    s_add_u32 s48, s48, s49
    s_lshl_b32 s49, s9, 12
    s_add_u32 s48, s48, s49
    s_add_u32 s48, s48, 68485120
    s_add_u32 s12, s4, s48
    s_addc_u32 s13, s5, 0
    s_mov_b32 m0, s49
    s_mul_i32 s50, s7, 80
    s_mul_i32 s51, s6, 20
    s_add_u32 s50, s50, s51
    s_add_u32 s50, s50, 67203072
    s_add_u32 s54, s4, s50
    s_addc_u32 s55, s5, 0
    s_add_u32 s56, s4, 71106560
    s_addc_u32 s57, s5, 0
    v_mbcnt_lo_u32_b32 v15, -1, 0
    v_mbcnt_hi_u32_b32 v15, -1, v15
    s_lshl_b32 s48, s9, 5
    v_add_u32 v13, s48, v15
    s_lshl_b32 s48, s9, 6
    v_add_u32 v21, s48, v15
    s_mov_b32 s48, 2560
    v_mul_lo_u32 v13, v13, s48
    v_lshlrev_b32 v15, 2, v21
    v_mov_b32 v3, 0
    v_mov_b32 v4, 0
    v_mov_b32 v5, 0
    v_mov_b32 v0, 0
    v_mov_b32 v127, 0
    v_mov_b32 v20, 0
    s_mov_b64 exec, s[68:69]
    s_cbranch_execz gem_acc_kernel_nooff
    global_load_dword v3, v13, s[54:55] offset:0
    global_load_dword v4, v13, s[54:55] offset:4
    global_load_dword v5, v13, s[54:55] offset:8
    global_load_dword v0, v13, s[54:55] offset:12
    global_load_dword v127, v13, s[54:55] offset:16
gem_acc_kernel_nooff:
    s_mov_b64 exec, -1
    v_cmp_gt_u32 vcc, 250, v21
    s_and_saveexec_b64 s[66:67], vcc
    s_cbranch_execz gem_acc_kernel_nomax
    global_load_dword v20, v15, s[56:57]
gem_acc_kernel_nomax:
    s_mov_b64 exec, s[66:67]
    global_load_lds_dwordx4 v12, s[12:13] offset:0
    global_load_lds_dwordx4 v12, s[12:13] offset:1024
    global_load_lds_dwordx4 v12, s[12:13] offset:2048
    global_load_lds_dwordx4 v12, s[12:13] offset:3072
    s_add_u32 s12, s12, 64000
    s_addc_u32 s13, s13, 0
    v_mov_b32 v24, 0x40000000
    v_mov_b32 v25, v24
    v_mov_b32 v26, v24
    v_mov_b32 v27, v24
    v_lshlrev_b32 v13, 4, v21
    v_add_u32 v13, 65536, v13
    ds_write_b128 v13, v[24:27] offset:0
    ds_write_b128 v13, v[24:27] offset:16384
    ds_write_b128 v13, v[24:27] offset:32768
    ds_write_b128 v13, v[24:27] offset:49152
    v_add_u32 v13, 65536, v13
    v_cmp_gt_u32 vcc, 904, v21
    s_and_saveexec_b64 s[66:67], vcc
    ds_write_b128 v13, v[24:27]
    s_mov_b64 exec, s[66:67]
    v_mov_b32 v13, 145600
    v_mov_b32 v15, 0
    ds_write_b32 v13, v15
    v_mov_b32 v11, 0
    s_waitcnt vmcnt(4)
    v_mov_b32 v22, 0
    v_mov_b32 v23, 0
    v_mov_b32 v24, 0
    v_mov_b32 v25, 0
    v_mov_b32 v26, 0
    v_mov_b32 v27, 0
    v_mov_b32 v28, 0
    v_mov_b32 v29, 0
    v_mov_b32 v30, 0
    v_mov_b32 v31, 0
    v_mov_b32 v32, 0
    v_mov_b32 v33, 0
    v_mov_b32 v34, 0
    v_mov_b32 v35, 0
    v_mov_b32 v36, 0
    v_mov_b32 v37, 0
    s_nop 1
    v_max_u32_dpp v20, v20, v20 row_shr:1 row_mask:0xf bank_mask:0xf
    s_nop 1
    v_max_u32_dpp v20, v20, v20 row_shr:2 row_mask:0xf bank_mask:0xf
    s_nop 1
    v_max_u32_dpp v20, v20, v20 row_shr:4 row_mask:0xf bank_mask:0xf
    s_nop 1
    v_max_u32_dpp v20, v20, v20 row_shr:8 row_mask:0xf bank_mask:0xf
    s_nop 1
    v_max_u32_dpp v20, v20, v20 row_bcast:15 row_mask:0xa bank_mask:0xf
    s_nop 1
    v_max_u32_dpp v20, v20, v20 row_bcast:31 row_mask:0xc bank_mask:0xf
    s_nop 1
    v_readlane_b32 s48, v20, 63
    s_lshl_b32 s49, s9, 2
    s_add_u32 s49, s49, 145536
    v_mov_b32 v13, s49
    v_mov_b32 v15, s48
    ds_write_b32 v13, v15
    s_mov_b32 s83, 0
    v_and_b32 v13, 0xffff, v3
    v_lshrrev_b32 v15, 16, v3
    v_mov_b32 v3, v4
    v_mov_b32 v4, v5
    v_mov_b32 v5, v0
    v_mov_b32 v0, v127
    v_sub_u32 v15, v15, v13
    v_mov_b32 v21, v15
    s_nop 1
    v_add_u32_dpp v21, v21, v21 row_shr:1 row_mask:0xf bank_mask:0xf
    s_nop 1
    v_add_u32_dpp v21, v21, v21 row_shr:2 row_mask:0xf bank_mask:0xf
    s_nop 1
    v_add_u32_dpp v21, v21, v21 row_shr:4 row_mask:0xf bank_mask:0xf
    s_nop 1
    v_add_u32_dpp v21, v21, v21 row_shr:8 row_mask:0xf bank_mask:0xf
    s_nop 1
    v_add_u32_dpp v21, v21, v21 row_bcast:15 row_mask:0xa bank_mask:0xf
    s_nop 1
    v_add_u32_dpp v21, v21, v21 row_bcast:31 row_mask:0xc bank_mask:0xf
    s_nop 1
    v_readlane_b32 s79, v21, 63
    v_sub_u32 v21, v21, v15
    v_add_u32 v15, -1, v15
    v_and_b32 v15, 0x40000000, v15
    v_lshl_or_b32 v6, v21, 2, v15
    v_sub_u32 v13, v13, v21
    v_mad_i32_i24 v7, v13, 24, v2
    v_mov_b32 v8, v1
    s_mov_b32 s80, 0
    s_min_u32 s84, s79, 315
    s_sub_u32 s79, s79, s84
    s_cmp_eq_u32 s79, 0
    s_cselect_b32 s82, 1, 0
    s_add_u32 s49, s84, 62
    s_mul_hi_u32 s81, s49, 68174085
    v_min_u32 v122, 252, v6
    v_add_u32 v6, -252, v6
    ds_permute_b32 v122, v122, v7
    v_min_u32 v123, 252, v6
    v_add_u32 v6, -252, v6
    ds_permute_b32 v123, v123, v7
    v_min_u32 v124, 252, v6
    v_add_u32 v6, -252, v6
    ds_permute_b32 v124, v124, v7
    v_min_u32 v125, 252, v6
    v_add_u32 v6, -252, v6
    ds_permute_b32 v125, v125, v7
    v_min_u32 v126, 252, v6
    v_add_u32 v6, -252, v6
    ds_permute_b32 v126, v126, v7
    s_waitcnt lgkmcnt(0)
    v_add_u32 v9, 4536, v8
    s_nop 1
    v_max_u32_dpp v122, v122, v122 row_shr:1 row_mask:0xf bank_mask:0xf
    v_max_u32_dpp v123, v123, v123 row_shr:1 row_mask:0xf bank_mask:0xf
    v_max_u32_dpp v124, v124, v124 row_shr:1 row_mask:0xf bank_mask:0xf
    v_max_u32_dpp v125, v125, v125 row_shr:1 row_mask:0xf bank_mask:0xf
    v_max_u32_dpp v126, v126, v126 row_shr:1 row_mask:0xf bank_mask:0xf
    v_max_u32_dpp v122, v122, v122 row_shr:2 row_mask:0xf bank_mask:0xf
    v_max_u32_dpp v123, v123, v123 row_shr:2 row_mask:0xf bank_mask:0xf
    v_max_u32_dpp v124, v124, v124 row_shr:2 row_mask:0xf bank_mask:0xf
    v_max_u32_dpp v125, v125, v125 row_shr:2 row_mask:0xf bank_mask:0xf
    v_max_u32_dpp v126, v126, v126 row_shr:2 row_mask:0xf bank_mask:0xf
    v_max_u32_dpp v122, v122, v122 row_shr:4 row_mask:0xf bank_mask:0xf
    v_max_u32_dpp v123, v123, v123 row_shr:4 row_mask:0xf bank_mask:0xf
    v_max_u32_dpp v124, v124, v124 row_shr:4 row_mask:0xf bank_mask:0xf
    v_max_u32_dpp v125, v125, v125 row_shr:4 row_mask:0xf bank_mask:0xf
    v_max_u32_dpp v126, v126, v126 row_shr:4 row_mask:0xf bank_mask:0xf
    v_max_u32_dpp v122, v122, v122 row_shr:8 row_mask:0xf bank_mask:0xf
    v_max_u32_dpp v123, v123, v123 row_shr:8 row_mask:0xf bank_mask:0xf
    v_max_u32_dpp v124, v124, v124 row_shr:8 row_mask:0xf bank_mask:0xf
    v_max_u32_dpp v125, v125, v125 row_shr:8 row_mask:0xf bank_mask:0xf
    v_max_u32_dpp v126, v126, v126 row_shr:8 row_mask:0xf bank_mask:0xf
    v_max_u32_dpp v122, v122, v122 row_bcast:15 row_mask:0xa bank_mask:0xf
    v_max_u32_dpp v123, v123, v123 row_bcast:15 row_mask:0xa bank_mask:0xf
    v_max_u32_dpp v124, v124, v124 row_bcast:15 row_mask:0xa bank_mask:0xf
    v_max_u32_dpp v125, v125, v125 row_bcast:15 row_mask:0xa bank_mask:0xf
    v_max_u32_dpp v126, v126, v126 row_bcast:15 row_mask:0xa bank_mask:0xf
    v_max_u32_dpp v122, v122, v122 row_bcast:31 row_mask:0xc bank_mask:0xf
    v_max_u32_dpp v123, v123, v123 row_bcast:31 row_mask:0xc bank_mask:0xf
    v_max_u32_dpp v124, v124, v124 row_bcast:31 row_mask:0xc bank_mask:0xf
    v_max_u32_dpp v125, v125, v125 row_bcast:31 row_mask:0xc bank_mask:0xf
    v_max_u32_dpp v126, v126, v126 row_bcast:31 row_mask:0xc bank_mask:0xf
    v_readlane_b32 s60, v122, 62
    v_readlane_b32 s61, v123, 62
    v_readlane_b32 s62, v124, 62
    v_readlane_b32 s63, v125, 62
    v_readlane_b32 s64, v126, 62
    s_nop 1
    v_max_u32 v122, s80, v122
    s_max_u32 s60, s60, s80
    v_max_u32 v123, s60, v123
    s_max_u32 s61, s61, s60
    v_max_u32 v124, s61, v124
    s_max_u32 s62, s62, s61
    v_max_u32 v125, s62, v125
    s_max_u32 s63, s63, s62
    v_max_u32 v126, s63, v126
    s_max_u32 s64, s64, s63
    s_mov_b32 s80, s64
    v_add_u32 v122, v8, v122
    v_add_u32 v123, v8, v123
    v_add_u32 v124, v8, v124
    v_add_u32 v125, v9, v125
    v_add_u32 v126, v9, v126
    v_add_u32 v8, 7560, v8
    s_mov_b32 s22, s81
    s_mov_b32 s23, s82
    s_mov_b32 s24, s83
    s_sub_i32 s50, s84, 0
    s_min_i32 s50, s50, 63
    s_max_i32 s50, s50, 1
    s_bfm_b64 s[28:29], s50, 0
    s_sub_i32 s50, s84, 63
    s_min_i32 s50, s50, 63
    s_max_i32 s50, s50, 1
    s_bfm_b64 s[30:31], s50, 0
    s_sub_i32 s50, s84, 126
    s_min_i32 s50, s50, 63
    s_max_i32 s50, s50, 1
    s_bfm_b64 s[32:33], s50, 0
    s_sub_i32 s50, s84, 189
    s_min_i32 s50, s50, 63
    s_max_i32 s50, s50, 1
    s_bfm_b64 s[34:35], s50, 0
    s_sub_i32 s50, s84, 252
    s_min_i32 s50, s50, 63
    s_max_i32 s50, s50, 1
    s_bfm_b64 s[36:37], s50, 0
    s_mov_b64 exec, s[28:29]
    global_load_dwordx4 v[58:61], v122, s[10:11] offset:0
    global_load_dwordx2 v[62:63], v122, s[10:11] offset:16
    s_mov_b64 exec, -1
    s_mov_b64 exec, s[30:31]
    global_load_dwordx4 v[64:67], v123, s[10:11] offset:1512
    global_load_dwordx2 v[68:69], v123, s[10:11] offset:1528
    s_mov_b64 exec, -1
    s_waitcnt vmcnt(4) lgkmcnt(0)
    s_barrier
    s_mov_b64 exec, s[32:33]
    global_load_dwordx4 v[70:73], v124, s[10:11] offset:3024
    global_load_dwordx2 v[74:75], v124, s[10:11] offset:3040
    s_mov_b64 exec, -1
    s_mov_b64 exec, s[34:35]
    global_load_dwordx4 v[76:79], v125, s[10:11] offset:0
    global_load_dwordx2 v[80:81], v125, s[10:11] offset:16
    s_mov_b64 exec, -1
    s_mov_b64 exec, s[36:37]
    global_load_dwordx4 v[82:85], v126, s[10:11] offset:1512
    global_load_dwordx2 v[86:87], v126, s[10:11] offset:1528
    s_mov_b64 exec, -1
    v_mbcnt_lo_u32_b32 v13, -1, 0
    v_mbcnt_hi_u32_b32 v13, -1, v13
    v_and_b32 v13, 15, v13
    v_lshlrev_b32 v13, 2, v13
    v_add_u32 v13, 145536, v13
    ds_read_b32 v10, v13
    s_cmp_eq_u32 s82, 0
    s_cbranch_scc1 gem_acc_kernel_p1_same
    s_add_u32 s83, s83, 1
    s_cmp_ge_u32 s83, 5
    s_cbranch_scc1 gem_acc_kernel_p1_none
    v_and_b32 v13, 0xffff, v3
    v_lshrrev_b32 v15, 16, v3
    v_mov_b32 v3, v4
    v_mov_b32 v4, v5
    v_mov_b32 v5, v0
    v_mov_b32 v0, v127
    v_sub_u32 v15, v15, v13
    v_mov_b32 v21, v15
    s_nop 1
    v_add_u32_dpp v21, v21, v21 row_shr:1 row_mask:0xf bank_mask:0xf
    s_nop 1
    v_add_u32_dpp v21, v21, v21 row_shr:2 row_mask:0xf bank_mask:0xf
    s_nop 1
    v_add_u32_dpp v21, v21, v21 row_shr:4 row_mask:0xf bank_mask:0xf
    s_nop 1
    v_add_u32_dpp v21, v21, v21 row_shr:8 row_mask:0xf bank_mask:0xf
    s_nop 1
    v_add_u32_dpp v21, v21, v21 row_bcast:15 row_mask:0xa bank_mask:0xf
    s_nop 1
    v_add_u32_dpp v21, v21, v21 row_bcast:31 row_mask:0xc bank_mask:0xf
    s_nop 1
    v_readlane_b32 s79, v21, 63
    v_sub_u32 v21, v21, v15
    v_add_u32 v15, -1, v15
    v_and_b32 v15, 0x40000000, v15
    v_lshl_or_b32 v6, v21, 2, v15
    v_sub_u32 v13, v13, v21
    v_mad_i32_i24 v7, v13, 24, v2
    v_mov_b32 v8, v1
    s_mov_b32 s80, 0
    s_branch gem_acc_kernel_p1_same
gem_acc_kernel_p1_none:
    s_mov_b32 s83, 5
    s_mov_b32 s79, 0
gem_acc_kernel_p1_same:
    s_min_u32 s84, s79, 315
    s_sub_u32 s79, s79, s84
    s_cmp_eq_u32 s79, 0
    s_cselect_b32 s82, 1, 0
    s_add_u32 s49, s84, 62
    s_mul_hi_u32 s81, s49, 68174085
    v_min_u32 v122, 252, v6
    v_add_u32 v6, -252, v6
    ds_permute_b32 v122, v122, v7
    v_min_u32 v123, 252, v6
    v_add_u32 v6, -252, v6
    ds_permute_b32 v123, v123, v7
    v_min_u32 v124, 252, v6
    v_add_u32 v6, -252, v6
    ds_permute_b32 v124, v124, v7
    v_min_u32 v125, 252, v6
    v_add_u32 v6, -252, v6
    ds_permute_b32 v125, v125, v7
    v_min_u32 v126, 252, v6
    v_add_u32 v6, -252, v6
    ds_permute_b32 v126, v126, v7
    s_waitcnt lgkmcnt(0)
    v_add_u32 v9, 4536, v8
    s_nop 1
    v_max_u32_dpp v122, v122, v122 row_shr:1 row_mask:0xf bank_mask:0xf
    v_max_u32_dpp v123, v123, v123 row_shr:1 row_mask:0xf bank_mask:0xf
    v_max_u32_dpp v124, v124, v124 row_shr:1 row_mask:0xf bank_mask:0xf
    v_max_u32_dpp v125, v125, v125 row_shr:1 row_mask:0xf bank_mask:0xf
    v_max_u32_dpp v126, v126, v126 row_shr:1 row_mask:0xf bank_mask:0xf
    v_max_u32_dpp v122, v122, v122 row_shr:2 row_mask:0xf bank_mask:0xf
    v_max_u32_dpp v123, v123, v123 row_shr:2 row_mask:0xf bank_mask:0xf
    v_max_u32_dpp v124, v124, v124 row_shr:2 row_mask:0xf bank_mask:0xf
    v_max_u32_dpp v125, v125, v125 row_shr:2 row_mask:0xf bank_mask:0xf
    v_max_u32_dpp v126, v126, v126 row_shr:2 row_mask:0xf bank_mask:0xf
    v_max_u32_dpp v122, v122, v122 row_shr:4 row_mask:0xf bank_mask:0xf
    v_max_u32_dpp v123, v123, v123 row_shr:4 row_mask:0xf bank_mask:0xf
    v_max_u32_dpp v124, v124, v124 row_shr:4 row_mask:0xf bank_mask:0xf
    v_max_u32_dpp v125, v125, v125 row_shr:4 row_mask:0xf bank_mask:0xf
    v_max_u32_dpp v126, v126, v126 row_shr:4 row_mask:0xf bank_mask:0xf
    v_max_u32_dpp v122, v122, v122 row_shr:8 row_mask:0xf bank_mask:0xf
    v_max_u32_dpp v123, v123, v123 row_shr:8 row_mask:0xf bank_mask:0xf
    v_max_u32_dpp v124, v124, v124 row_shr:8 row_mask:0xf bank_mask:0xf
    v_max_u32_dpp v125, v125, v125 row_shr:8 row_mask:0xf bank_mask:0xf
    v_max_u32_dpp v126, v126, v126 row_shr:8 row_mask:0xf bank_mask:0xf
    v_max_u32_dpp v122, v122, v122 row_bcast:15 row_mask:0xa bank_mask:0xf
    v_max_u32_dpp v123, v123, v123 row_bcast:15 row_mask:0xa bank_mask:0xf
    v_max_u32_dpp v124, v124, v124 row_bcast:15 row_mask:0xa bank_mask:0xf
    v_max_u32_dpp v125, v125, v125 row_bcast:15 row_mask:0xa bank_mask:0xf
    v_max_u32_dpp v126, v126, v126 row_bcast:15 row_mask:0xa bank_mask:0xf
    v_max_u32_dpp v122, v122, v122 row_bcast:31 row_mask:0xc bank_mask:0xf
    v_max_u32_dpp v123, v123, v123 row_bcast:31 row_mask:0xc bank_mask:0xf
    v_max_u32_dpp v124, v124, v124 row_bcast:31 row_mask:0xc bank_mask:0xf
    v_max_u32_dpp v125, v125, v125 row_bcast:31 row_mask:0xc bank_mask:0xf
    v_max_u32_dpp v126, v126, v126 row_bcast:31 row_mask:0xc bank_mask:0xf
    v_readlane_b32 s60, v122, 62
    v_readlane_b32 s61, v123, 62
    v_readlane_b32 s62, v124, 62
    v_readlane_b32 s63, v125, 62
    v_readlane_b32 s64, v126, 62
    s_nop 1
    v_max_u32 v122, s80, v122
    s_max_u32 s60, s60, s80
    v_max_u32 v123, s60, v123
    s_max_u32 s61, s61, s60
    v_max_u32 v124, s61, v124
    s_max_u32 s62, s62, s61
    v_max_u32 v125, s62, v125
    s_max_u32 s63, s63, s62
    v_max_u32 v126, s63, v126
    s_max_u32 s64, s64, s63
    s_mov_b32 s80, s64
    v_add_u32 v122, v8, v122
    v_add_u32 v123, v8, v123
    v_add_u32 v124, v8, v124
    v_add_u32 v125, v9, v125
    v_add_u32 v126, v9, v126
    v_add_u32 v8, 7560, v8
    s_mov_b32 s25, s81
    s_mov_b32 s26, s82
    s_mov_b32 s27, s83
    s_mov_b32 s78, s84
    s_sub_i32 s50, s84, 0
    s_min_i32 s50, s50, 63
    s_max_i32 s50, s50, 1
    s_bfm_b64 s[38:39], s50, 0
    s_sub_i32 s50, s84, 63
    s_min_i32 s50, s50, 63
    s_max_i32 s50, s50, 1
    s_bfm_b64 s[40:41], s50, 0
    s_sub_i32 s50, s84, 126
    s_min_i32 s50, s50, 63
    s_max_i32 s50, s50, 1
    s_bfm_b64 s[42:43], s50, 0
    s_sub_i32 s50, s84, 189
    s_min_i32 s50, s50, 63
    s_max_i32 s50, s50, 1
    s_bfm_b64 s[44:45], s50, 0
    s_sub_i32 s50, s84, 252
    s_min_i32 s50, s50, 63
    s_max_i32 s50, s50, 1
    s_bfm_b64 s[46:47], s50, 0
    s_cmp_eq_u32 s82, 0
    s_cbranch_scc1 gem_acc_kernel_p2_same
    s_add_u32 s83, s83, 1
    s_cmp_ge_u32 s83, 5
    s_cbranch_scc1 gem_acc_kernel_p2_none
    v_and_b32 v13, 0xffff, v3
    v_lshrrev_b32 v15, 16, v3
    v_mov_b32 v3, v4
    v_mov_b32 v4, v5
    v_mov_b32 v5, v0
    v_mov_b32 v0, v127
    v_sub_u32 v15, v15, v13
    v_mov_b32 v21, v15
    s_nop 1
    v_add_u32_dpp v21, v21, v21 row_shr:1 row_mask:0xf bank_mask:0xf
    s_nop 1
    v_add_u32_dpp v21, v21, v21 row_shr:2 row_mask:0xf bank_mask:0xf
    s_nop 1
    v_add_u32_dpp v21, v21, v21 row_shr:4 row_mask:0xf bank_mask:0xf
    s_nop 1
    v_add_u32_dpp v21, v21, v21 row_shr:8 row_mask:0xf bank_mask:0xf
    s_nop 1
    v_add_u32_dpp v21, v21, v21 row_bcast:15 row_mask:0xa bank_mask:0xf
    s_nop 1
    v_add_u32_dpp v21, v21, v21 row_bcast:31 row_mask:0xc bank_mask:0xf
    s_nop 1
    v_readlane_b32 s79, v21, 63
    v_sub_u32 v21, v21, v15
    v_add_u32 v15, -1, v15
    v_and_b32 v15, 0x40000000, v15
    v_lshl_or_b32 v6, v21, 2, v15
    v_sub_u32 v13, v13, v21
    v_mad_i32_i24 v7, v13, 24, v2
    v_mov_b32 v8, v1
    s_mov_b32 s80, 0
    s_branch gem_acc_kernel_p2_same
gem_acc_kernel_p2_none:
    s_mov_b32 s83, 5
    s_mov_b32 s79, 0
gem_acc_kernel_p2_same:
    s_min_u32 s84, s79, 315
    s_sub_u32 s79, s79, s84
    s_cmp_eq_u32 s79, 0
    s_cselect_b32 s82, 1, 0
    s_add_u32 s49, s84, 62
    s_mul_hi_u32 s81, s49, 68174085
    v_min_u32 v16, 252, v6
    v_add_u32 v6, -252, v6
    ds_permute_b32 v16, v16, v7
    v_min_u32 v17, 252, v6
    v_add_u32 v6, -252, v6
    ds_permute_b32 v17, v17, v7
    v_min_u32 v18, 252, v6
    v_add_u32 v6, -252, v6
    ds_permute_b32 v18, v18, v7
    v_min_u32 v19, 252, v6
    v_add_u32 v6, -252, v6
    ds_permute_b32 v19, v19, v7
    v_min_u32 v20, 252, v6
    v_add_u32 v6, -252, v6
    ds_permute_b32 v20, v20, v7
    s_waitcnt lgkmcnt(0)
    v_add_u32 v9, 4536, v8
    s_nop 1
    v_max_u32_dpp v16, v16, v16 row_shr:1 row_mask:0xf bank_mask:0xf
    v_max_u32_dpp v17, v17, v17 row_shr:1 row_mask:0xf bank_mask:0xf
    v_max_u32_dpp v18, v18, v18 row_shr:1 row_mask:0xf bank_mask:0xf
    v_max_u32_dpp v19, v19, v19 row_shr:1 row_mask:0xf bank_mask:0xf
    v_max_u32_dpp v20, v20, v20 row_shr:1 row_mask:0xf bank_mask:0xf
    v_max_u32_dpp v16, v16, v16 row_shr:2 row_mask:0xf bank_mask:0xf
    v_max_u32_dpp v17, v17, v17 row_shr:2 row_mask:0xf bank_mask:0xf
    v_max_u32_dpp v18, v18, v18 row_shr:2 row_mask:0xf bank_mask:0xf
    v_max_u32_dpp v19, v19, v19 row_shr:2 row_mask:0xf bank_mask:0xf
    v_max_u32_dpp v20, v20, v20 row_shr:2 row_mask:0xf bank_mask:0xf
    v_max_u32_dpp v16, v16, v16 row_shr:4 row_mask:0xf bank_mask:0xf
    v_max_u32_dpp v17, v17, v17 row_shr:4 row_mask:0xf bank_mask:0xf
    v_max_u32_dpp v18, v18, v18 row_shr:4 row_mask:0xf bank_mask:0xf
    v_max_u32_dpp v19, v19, v19 row_shr:4 row_mask:0xf bank_mask:0xf
    v_max_u32_dpp v20, v20, v20 row_shr:4 row_mask:0xf bank_mask:0xf
    v_max_u32_dpp v16, v16, v16 row_shr:8 row_mask:0xf bank_mask:0xf
    v_max_u32_dpp v17, v17, v17 row_shr:8 row_mask:0xf bank_mask:0xf
    v_max_u32_dpp v18, v18, v18 row_shr:8 row_mask:0xf bank_mask:0xf
    v_max_u32_dpp v19, v19, v19 row_shr:8 row_mask:0xf bank_mask:0xf
    v_max_u32_dpp v20, v20, v20 row_shr:8 row_mask:0xf bank_mask:0xf
    v_max_u32_dpp v16, v16, v16 row_bcast:15 row_mask:0xa bank_mask:0xf
    v_max_u32_dpp v17, v17, v17 row_bcast:15 row_mask:0xa bank_mask:0xf
    v_max_u32_dpp v18, v18, v18 row_bcast:15 row_mask:0xa bank_mask:0xf
    v_max_u32_dpp v19, v19, v19 row_bcast:15 row_mask:0xa bank_mask:0xf
    v_max_u32_dpp v20, v20, v20 row_bcast:15 row_mask:0xa bank_mask:0xf
    v_max_u32_dpp v16, v16, v16 row_bcast:31 row_mask:0xc bank_mask:0xf
    v_max_u32_dpp v17, v17, v17 row_bcast:31 row_mask:0xc bank_mask:0xf
    v_max_u32_dpp v18, v18, v18 row_bcast:31 row_mask:0xc bank_mask:0xf
    v_max_u32_dpp v19, v19, v19 row_bcast:31 row_mask:0xc bank_mask:0xf
    v_max_u32_dpp v20, v20, v20 row_bcast:31 row_mask:0xc bank_mask:0xf
    v_readlane_b32 s60, v16, 62
    v_readlane_b32 s61, v17, 62
    v_readlane_b32 s62, v18, 62
    v_readlane_b32 s63, v19, 62
    v_readlane_b32 s64, v20, 62
    s_nop 1
    v_max_u32 v16, s80, v16
    s_max_u32 s60, s60, s80
    v_max_u32 v17, s60, v17
    s_max_u32 s61, s61, s60
    v_max_u32 v18, s61, v18
    s_max_u32 s62, s62, s61
    v_max_u32 v19, s62, v19
    s_max_u32 s63, s63, s62
    v_max_u32 v20, s63, v20
    s_max_u32 s64, s64, s63
    s_mov_b32 s80, s64
    v_add_u32 v16, v8, v16
    v_add_u32 v17, v8, v17
    v_add_u32 v18, v8, v18
    v_add_u32 v19, v9, v19
    v_add_u32 v20, v9, v20
    v_add_u32 v8, 7560, v8
    s_nop 1
    v_max_u32_dpp v10, v10, v10 row_shr:1 row_mask:0xf bank_mask:0xf
    s_nop 1
    v_max_u32_dpp v10, v10, v10 row_shr:2 row_mask:0xf bank_mask:0xf
    s_nop 1
    v_max_u32_dpp v10, v10, v10 row_shr:4 row_mask:0xf bank_mask:0xf
    s_nop 1
    v_max_u32_dpp v10, v10, v10 row_shr:8 row_mask:0xf bank_mask:0xf
    s_nop 1
    v_readlane_b32 s48, v10, 15
    s_nop 3
    s_lshr_b32 s48, s48, 23
    s_lshl_b32 s49, s14, 2
    s_add_u32 s48, s48, s49
    s_sub_i32 s48, 275, s48
    s_min_i32 s48, s48, 254
    s_max_i32 s48, s48, 1
    s_sub_i32 s49, 254, s48
    s_lshl_b32 s48, s48, 23
    s_lshl_b32 s15, s49, 23
    v_mov_b32 v10, s48
    s_mov_b32 s19, 0
    s_mov_b32 s21, s19
    s_mov_b32 s18, s22
    s_mov_b32 s19, s23
    s_mov_b32 s20, s24
    s_mov_b32 s22, s25
    s_mov_b32 s23, s26
    s_mov_b32 s24, s27
    s_mov_b32 s85, s78
    s_mov_b32 s25, s81
    s_mov_b32 s26, s82
    s_mov_b32 s27, s83
    s_mov_b32 s78, s84
    s_cmp_eq_u32 s21, 0
    s_cbranch_scc1 gem_acc_kernel_P_noB
    s_barrier
gem_acc_kernel_P_noB:
    s_waitcnt vmcnt(9)
    s_setprio 3
    s_mov_b64 exec, s[28:29]
    v_and_b32 v13, 0xffff, v58
    ds_read_b32 v38, v13
    v_lshrrev_b32 v58, 13, v58
    v_and_b32 v58, 0x1fff8, v58
    v_and_b32 v15, 0xffff, v59
    ds_read_b32 v39, v15
    v_lshrrev_b32 v59, 13, v59
    v_and_b32 v59, 0x1fff8, v59
    v_and_b32 v13, 0xffff, v60
    ds_read_b32 v40, v13
    v_lshrrev_b32 v60, 13, v60
    v_and_b32 v60, 0x1fff8, v60
    v_and_b32 v15, 0xffff, v61
    ds_read_b32 v41, v15
    v_lshrrev_b32 v61, 13, v61
    v_and_b32 v61, 0x1fff8, v61
    s_mov_b64 exec, -1
    s_mov_b64 exec, s[38:39]
    global_load_dwordx4 v[88:91], v122, s[10:11] offset:0
    global_load_dwordx2 v[92:93], v122, s[10:11] offset:16
    s_mov_b64 exec, -1
    s_waitcnt vmcnt(9)
    s_setprio 2
    s_mov_b64 exec, s[30:31]
    v_and_b32 v13, 0xffff, v64
    ds_read_b32 v42, v13
    v_lshrrev_b32 v64, 13, v64
    v_and_b32 v64, 0x1fff8, v64
    v_and_b32 v15, 0xffff, v65
    ds_read_b32 v43, v15
    v_lshrrev_b32 v65, 13, v65
    v_and_b32 v65, 0x1fff8, v65
    v_and_b32 v13, 0xffff, v66
    ds_read_b32 v44, v13
    v_lshrrev_b32 v66, 13, v66
    v_and_b32 v66, 0x1fff8, v66
    v_and_b32 v15, 0xffff, v67
    ds_read_b32 v45, v15
    v_lshrrev_b32 v67, 13, v67
    v_and_b32 v67, 0x1fff8, v67
    s_mov_b64 exec, -1
    s_mov_b64 exec, s[40:41]
    global_load_dwordx4 v[94:97], v123, s[10:11] offset:1512
    global_load_dwordx2 v[98:99], v123, s[10:11] offset:1528
    s_mov_b64 exec, -1
    s_waitcnt vmcnt(9)
    s_setprio 1
    s_mov_b64 exec, s[32:33]
    v_and_b32 v13, 0xffff, v70
    ds_read_b32 v46, v13
    v_lshrrev_b32 v70, 13, v70
    v_and_b32 v70, 0x1fff8, v70
    v_and_b32 v15, 0xffff, v71
    ds_read_b32 v47, v15
    v_lshrrev_b32 v71, 13, v71
    v_and_b32 v71, 0x1fff8, v71
    v_and_b32 v13, 0xffff, v72
    ds_read_b32 v48, v13
    v_lshrrev_b32 v72, 13, v72
    v_and_b32 v72, 0x1fff8, v72
    v_and_b32 v15, 0xffff, v73
    ds_read_b32 v49, v15
    v_lshrrev_b32 v73, 13, v73
    v_and_b32 v73, 0x1fff8, v73
    s_mov_b64 exec, -1
    s_mov_b64 exec, s[42:43]
    global_load_dwordx4 v[100:103], v124, s[10:11] offset:3024
    global_load_dwordx2 v[104:105], v124, s[10:11] offset:3040
    s_mov_b64 exec, -1
    s_waitcnt vmcnt(9)
    s_setprio 0
    s_mov_b64 exec, s[34:35]
    v_and_b32 v13, 0xffff, v76
    ds_read_b32 v50, v13
    v_lshrrev_b32 v76, 13, v76
    v_and_b32 v76, 0x1fff8, v76
    v_and_b32 v15, 0xffff, v77
    ds_read_b32 v51, v15
    v_lshrrev_b32 v77, 13, v77
    v_and_b32 v77, 0x1fff8, v77
    v_and_b32 v13, 0xffff, v78
    ds_read_b32 v52, v13
    v_lshrrev_b32 v78, 13, v78
    v_and_b32 v78, 0x1fff8, v78
    v_and_b32 v15, 0xffff, v79
    ds_read_b32 v53, v15
    v_lshrrev_b32 v79, 13, v79
    v_and_b32 v79, 0x1fff8, v79
    s_mov_b64 exec, -1
    s_mov_b64 exec, s[44:45]
    global_load_dwordx4 v[106:109], v125, s[10:11] offset:0
    global_load_dwordx2 v[110:111], v125, s[10:11] offset:16
    s_mov_b64 exec, -1
    s_waitcnt vmcnt(9)
    s_mov_b64 exec, s[36:37]
    v_and_b32 v13, 0xffff, v82
    ds_read_b32 v54, v13
    v_lshrrev_b32 v82, 13, v82
    v_and_b32 v82, 0x1fff8, v82
    v_and_b32 v15, 0xffff, v83
    ds_read_b32 v55, v15
    v_lshrrev_b32 v83, 13, v83
    v_and_b32 v83, 0x1fff8, v83
    v_and_b32 v13, 0xffff, v84
    ds_read_b32 v56, v13
    v_lshrrev_b32 v84, 13, v84
    v_and_b32 v84, 0x1fff8, v84
    v_and_b32 v15, 0xffff, v85
    ds_read_b32 v57, v15
    v_lshrrev_b32 v85, 13, v85
    v_and_b32 v85, 0x1fff8, v85
    s_mov_b64 exec, -1
    s_mov_b64 exec, s[46:47]
    global_load_dwordx4 v[112:115], v126, s[10:11] offset:1512
    global_load_dwordx2 v[116:117], v126, s[10:11] offset:1528
    s_mov_b64 exec, -1
    s_waitcnt vmcnt(10)
    s_cmp_eq_u32 s82, 0
    s_cbranch_scc1 gem_acc_kernel_P_adv_same
    s_add_u32 s83, s83, 1
    s_cmp_ge_u32 s83, 5
    s_cbranch_scc1 gem_acc_kernel_P_adv_none
    v_and_b32 v13, 0xffff, v3
    v_lshrrev_b32 v15, 16, v3
    v_mov_b32 v3, v4
    v_mov_b32 v4, v5
    v_mov_b32 v5, v0
    v_mov_b32 v0, v127
    v_sub_u32 v15, v15, v13
    v_mov_b32 v21, v15
    s_nop 1
    v_add_u32_dpp v21, v21, v21 row_shr:1 row_mask:0xf bank_mask:0xf
    s_nop 1
    v_add_u32_dpp v21, v21, v21 row_shr:2 row_mask:0xf bank_mask:0xf
    s_nop 1
    v_add_u32_dpp v21, v21, v21 row_shr:4 row_mask:0xf bank_mask:0xf
    s_nop 1
    v_add_u32_dpp v21, v21, v21 row_shr:8 row_mask:0xf bank_mask:0xf
    s_nop 1
    v_add_u32_dpp v21, v21, v21 row_bcast:15 row_mask:0xa bank_mask:0xf
    s_nop 1
    v_add_u32_dpp v21, v21, v21 row_bcast:31 row_mask:0xc bank_mask:0xf
    s_nop 1
    v_readlane_b32 s79, v21, 63
    v_sub_u32 v21, v21, v15
    v_add_u32 v15, -1, v15
    v_and_b32 v15, 0x40000000, v15
    v_lshl_or_b32 v6, v21, 2, v15
    v_sub_u32 v13, v13, v21
    v_mad_i32_i24 v7, v13, 24, v2
    v_mov_b32 v8, v1
    s_mov_b32 s80, 0
    s_branch gem_acc_kernel_P_adv_same
gem_acc_kernel_P_adv_none:
    s_mov_b32 s83, 5
    s_mov_b32 s79, 0
gem_acc_kernel_P_adv_same:
    s_min_u32 s84, s79, 315
    s_sub_u32 s79, s79, s84
    s_cmp_eq_u32 s79, 0
    s_cselect_b32 s82, 1, 0
    s_add_u32 s49, s84, 62
    s_mul_hi_u32 s81, s49, 68174085
    v_min_u32 v122, 252, v6
    v_add_u32 v6, -252, v6
    ds_permute_b32 v122, v122, v7
    v_min_u32 v123, 252, v6
    v_add_u32 v6, -252, v6
    ds_permute_b32 v123, v123, v7
    v_min_u32 v124, 252, v6
    v_add_u32 v6, -252, v6
    ds_permute_b32 v124, v124, v7
    v_min_u32 v125, 252, v6
    v_add_u32 v6, -252, v6
    ds_permute_b32 v125, v125, v7
    v_min_u32 v126, 252, v6
    v_add_u32 v6, -252, v6
    ds_permute_b32 v126, v126, v7
    s_setprio 3
    s_waitcnt lgkmcnt(5)
    s_cmp_eq_u32 s19, 0
    s_cbranch_scc1 gem_acc_kernel_P_x
    s_barrier
    s_add_u32 s48, s20, 1
    s_cmp_ge_u32 s48, 5
    s_cbranch_scc1 gem_acc_kernel_P_x
    global_load_lds_dwordx4 v12, s[12:13] offset:0
    global_load_lds_dwordx4 v12, s[12:13] offset:1024
    global_load_lds_dwordx4 v12, s[12:13] offset:2048
    global_load_lds_dwordx4 v12, s[12:13] offset:3072
    s_add_u32 s12, s12, 64000
    s_addc_u32 s13, s13, 0
gem_acc_kernel_P_x:
    s_cmp_le_u32 s18, 0
    s_cbranch_scc1 gem_acc_kernel_P_xs0
    v_or3_b32 v11, v11, v22, v23
    v_or3_b32 v11, v11, v24, v25
    v_or3_b32 v11, v11, v26, v27
    v_or3_b32 v11, v11, v28, v29
    s_mov_b64 exec, s[28:29]
    v_lshlrev_b32 v118, 16, v62
    v_and_b32 v119, 0xffff0000, v62
    v_lshlrev_b32 v120, 16, v63
    v_and_b32 v121, 0xffff0000, v63
    v_mul_f32 v118, v10, v118
    v_mul_f32 v119, v10, v119
    v_mul_f32 v120, v10, v120
    v_mul_f32 v121, v10, v121
    v_lshlrev_b32 v13, 16, v38
    v_and_b32 v38, 0xffff0000, v38
    v_fmaak_f32 v22, v13, v118, 0x4b400000
    v_fmaak_f32 v23, v38, v118, 0x4b400000
    v_lshl_add_u64 v[22:23], v[22:23], 0, s[16:17]
    ds_add_rtn_u64 v[22:23], v58, v[22:23] offset:65528
    v_lshlrev_b32 v13, 16, v39
    v_and_b32 v39, 0xffff0000, v39
    v_fmaak_f32 v24, v13, v119, 0x4b400000
    v_fmaak_f32 v25, v39, v119, 0x4b400000
    v_lshl_add_u64 v[24:25], v[24:25], 0, s[16:17]
    ds_add_rtn_u64 v[24:25], v59, v[24:25] offset:65528
    v_lshlrev_b32 v13, 16, v40
    v_and_b32 v40, 0xffff0000, v40
    v_fmaak_f32 v26, v13, v120, 0x4b400000
    v_fmaak_f32 v27, v40, v120, 0x4b400000
    v_lshl_add_u64 v[26:27], v[26:27], 0, s[16:17]
    ds_add_rtn_u64 v[26:27], v60, v[26:27] offset:65528
    v_lshlrev_b32 v13, 16, v41
    v_and_b32 v41, 0xffff0000, v41
    v_fmaak_f32 v28, v13, v121, 0x4b400000
    v_fmaak_f32 v29, v41, v121, 0x4b400000
    v_lshl_add_u64 v[28:29], v[28:29], 0, s[16:17]
    ds_add_rtn_u64 v[28:29], v61, v[28:29] offset:65528
    s_mov_b64 exec, -1
gem_acc_kernel_P_xs0:
    s_sub_i32 s50, s78, 0
    s_min_i32 s50, s50, 63
    s_max_i32 s50, s50, 1
    s_bfm_b64 s[28:29], s50, 0
    s_mov_b64 exec, s[28:29]
    global_load_dwordx4 v[58:61], v16, s[10:11] offset:0
    global_load_dwordx2 v[62:63], v16, s[10:11] offset:16
    s_mov_b64 exec, -1
    s_cmp_gt_u32 s18, 0
    s_cbranch_scc1 L_wo_10_f
    s_waitcnt lgkmcnt(0)
    s_branch L_wo_10_d
L_wo_10_f:
    s_waitcnt lgkmcnt(4)
L_wo_10_d:
    v_add_u32 v9, 4536, v8
    s_nop 1
    v_max_u32_dpp v122, v122, v122 row_shr:1 row_mask:0xf bank_mask:0xf
    v_max_u32_dpp v123, v123, v123 row_shr:1 row_mask:0xf bank_mask:0xf
    v_max_u32_dpp v124, v124, v124 row_shr:1 row_mask:0xf bank_mask:0xf
    v_max_u32_dpp v125, v125, v125 row_shr:1 row_mask:0xf bank_mask:0xf
    v_max_u32_dpp v126, v126, v126 row_shr:1 row_mask:0xf bank_mask:0xf
    v_max_u32_dpp v122, v122, v122 row_shr:2 row_mask:0xf bank_mask:0xf
    v_max_u32_dpp v123, v123, v123 row_shr:2 row_mask:0xf bank_mask:0xf
    v_max_u32_dpp v124, v124, v124 row_shr:2 row_mask:0xf bank_mask:0xf
    v_max_u32_dpp v125, v125, v125 row_shr:2 row_mask:0xf bank_mask:0xf
    v_max_u32_dpp v126, v126, v126 row_shr:2 row_mask:0xf bank_mask:0xf
    v_max_u32_dpp v122, v122, v122 row_shr:4 row_mask:0xf bank_mask:0xf
    v_max_u32_dpp v123, v123, v123 row_shr:4 row_mask:0xf bank_mask:0xf
    v_max_u32_dpp v124, v124, v124 row_shr:4 row_mask:0xf bank_mask:0xf
    v_max_u32_dpp v125, v125, v125 row_shr:4 row_mask:0xf bank_mask:0xf
    v_max_u32_dpp v126, v126, v126 row_shr:4 row_mask:0xf bank_mask:0xf
    v_max_u32_dpp v122, v122, v122 row_shr:8 row_mask:0xf bank_mask:0xf
    v_max_u32_dpp v123, v123, v123 row_shr:8 row_mask:0xf bank_mask:0xf
    v_max_u32_dpp v124, v124, v124 row_shr:8 row_mask:0xf bank_mask:0xf
    v_max_u32_dpp v125, v125, v125 row_shr:8 row_mask:0xf bank_mask:0xf
    v_max_u32_dpp v126, v126, v126 row_shr:8 row_mask:0xf bank_mask:0xf
    v_max_u32_dpp v122, v122, v122 row_bcast:15 row_mask:0xa bank_mask:0xf
    v_max_u32_dpp v123, v123, v123 row_bcast:15 row_mask:0xa bank_mask:0xf
    v_max_u32_dpp v124, v124, v124 row_bcast:15 row_mask:0xa bank_mask:0xf
    v_max_u32_dpp v125, v125, v125 row_bcast:15 row_mask:0xa bank_mask:0xf
    v_max_u32_dpp v126, v126, v126 row_bcast:15 row_mask:0xa bank_mask:0xf
    v_max_u32_dpp v122, v122, v122 row_bcast:31 row_mask:0xc bank_mask:0xf
    v_max_u32_dpp v123, v123, v123 row_bcast:31 row_mask:0xc bank_mask:0xf
    v_max_u32_dpp v124, v124, v124 row_bcast:31 row_mask:0xc bank_mask:0xf
    v_max_u32_dpp v125, v125, v125 row_bcast:31 row_mask:0xc bank_mask:0xf
    v_max_u32_dpp v126, v126, v126 row_bcast:31 row_mask:0xc bank_mask:0xf
    v_readlane_b32 s60, v122, 62
    v_readlane_b32 s61, v123, 62
    v_readlane_b32 s62, v124, 62
    v_readlane_b32 s63, v125, 62
    v_readlane_b32 s64, v126, 62
    s_nop 1
    v_max_u32 v122, s80, v122
    s_max_u32 s60, s60, s80
    v_max_u32 v123, s60, v123
    s_max_u32 s61, s61, s60
    v_max_u32 v124, s61, v124
    s_max_u32 s62, s62, s61
    v_max_u32 v125, s62, v125
    s_max_u32 s63, s63, s62
    v_max_u32 v126, s63, v126
    s_max_u32 s64, s64, s63
    s_mov_b32 s80, s64
    v_add_u32 v122, v8, v122
    v_add_u32 v123, v8, v123
    v_add_u32 v124, v8, v124
    v_add_u32 v125, v9, v125
    v_add_u32 v126, v9, v126
    v_add_u32 v8, 7560, v8
    s_setprio 2
    s_cmp_le_u32 s18, 1
    s_cbranch_scc1 gem_acc_kernel_P_xs1
    v_or3_b32 v11, v11, v30, v31
    v_or3_b32 v11, v11, v32, v33
    v_or3_b32 v11, v11, v34, v35
    v_or3_b32 v11, v11, v36, v37
    s_mov_b64 exec, s[30:31]
    v_lshlrev_b32 v118, 16, v68
    v_and_b32 v119, 0xffff0000, v68
    v_lshlrev_b32 v120, 16, v69
    v_and_b32 v121, 0xffff0000, v69
    v_mul_f32 v118, v10, v118
    v_mul_f32 v119, v10, v119
    v_mul_f32 v120, v10, v120
    v_mul_f32 v121, v10, v121
    v_lshlrev_b32 v13, 16, v42
    v_and_b32 v42, 0xffff0000, v42
    v_fmaak_f32 v30, v13, v118, 0x4b400000
    v_fmaak_f32 v31, v42, v118, 0x4b400000
    v_lshl_add_u64 v[30:31], v[30:31], 0, s[16:17]
    ds_add_rtn_u64 v[30:31], v64, v[30:31] offset:65528
    v_lshlrev_b32 v13, 16, v43
    v_and_b32 v43, 0xffff0000, v43
    v_fmaak_f32 v32, v13, v119, 0x4b400000
    v_fmaak_f32 v33, v43, v119, 0x4b400000
    v_lshl_add_u64 v[32:33], v[32:33], 0, s[16:17]
    ds_add_rtn_u64 v[32:33], v65, v[32:33] offset:65528
    v_lshlrev_b32 v13, 16, v44
    v_and_b32 v44, 0xffff0000, v44
    v_fmaak_f32 v34, v13, v120, 0x4b400000
    v_fmaak_f32 v35, v44, v120, 0x4b400000
    v_lshl_add_u64 v[34:35], v[34:35], 0, s[16:17]
    ds_add_rtn_u64 v[34:35], v66, v[34:35] offset:65528
    v_lshlrev_b32 v13, 16, v45
    v_and_b32 v45, 0xffff0000, v45
    v_fmaak_f32 v36, v13, v121, 0x4b400000
    v_fmaak_f32 v37, v45, v121, 0x4b400000
    v_lshl_add_u64 v[36:37], v[36:37], 0, s[16:17]
    ds_add_rtn_u64 v[36:37], v67, v[36:37] offset:65528
    s_mov_b64 exec, -1
gem_acc_kernel_P_xs1:
    s_sub_i32 s50, s78, 63
    s_min_i32 s50, s50, 63
    s_max_i32 s50, s50, 1
    s_bfm_b64 s[30:31], s50, 0
    s_mov_b64 exec, s[30:31]
    global_load_dwordx4 v[64:67], v17, s[10:11] offset:1512
    global_load_dwordx2 v[68:69], v17, s[10:11] offset:1528
    s_mov_b64 exec, -1
    s_setprio 1
    s_cmp_le_u32 s18, 2
    s_cbranch_scc1 gem_acc_kernel_P_xs2
    s_waitcnt lgkmcnt(4)
    v_or3_b32 v11, v11, v22, v23
    v_or3_b32 v11, v11, v24, v25
    v_or3_b32 v11, v11, v26, v27
    v_or3_b32 v11, v11, v28, v29
    s_mov_b64 exec, s[32:33]
    v_lshlrev_b32 v118, 16, v74
    v_and_b32 v119, 0xffff0000, v74
    v_lshlrev_b32 v120, 16, v75
    v_and_b32 v121, 0xffff0000, v75
    v_mul_f32 v118, v10, v118
    v_mul_f32 v119, v10, v119
    v_mul_f32 v120, v10, v120
    v_mul_f32 v121, v10, v121
    v_lshlrev_b32 v13, 16, v46
    v_and_b32 v46, 0xffff0000, v46
    v_fmaak_f32 v22, v13, v118, 0x4b400000
    v_fmaak_f32 v23, v46, v118, 0x4b400000
    v_lshl_add_u64 v[22:23], v[22:23], 0, s[16:17]
    ds_add_rtn_u64 v[22:23], v70, v[22:23] offset:65528
    v_lshlrev_b32 v13, 16, v47
    v_and_b32 v47, 0xffff0000, v47
    v_fmaak_f32 v24, v13, v119, 0x4b400000
    v_fmaak_f32 v25, v47, v119, 0x4b400000
    v_lshl_add_u64 v[24:25], v[24:25], 0, s[16:17]
    ds_add_rtn_u64 v[24:25], v71, v[24:25] offset:65528
    v_lshlrev_b32 v13, 16, v48
    v_and_b32 v48, 0xffff0000, v48
    v_fmaak_f32 v26, v13, v120, 0x4b400000
    v_fmaak_f32 v27, v48, v120, 0x4b400000
    v_lshl_add_u64 v[26:27], v[26:27], 0, s[16:17]
    ds_add_rtn_u64 v[26:27], v72, v[26:27] offset:65528
    v_lshlrev_b32 v13, 16, v49
    v_and_b32 v49, 0xffff0000, v49
    v_fmaak_f32 v28, v13, v121, 0x4b400000
    v_fmaak_f32 v29, v49, v121, 0x4b400000
    v_lshl_add_u64 v[28:29], v[28:29], 0, s[16:17]
    ds_add_rtn_u64 v[28:29], v73, v[28:29] offset:65528
    s_mov_b64 exec, -1
gem_acc_kernel_P_xs2:
    s_sub_i32 s50, s78, 126
    s_min_i32 s50, s50, 63
    s_max_i32 s50, s50, 1
    s_bfm_b64 s[32:33], s50, 0
    s_mov_b64 exec, s[32:33]
    global_load_dwordx4 v[70:73], v18, s[10:11] offset:3024
    global_load_dwordx2 v[74:75], v18, s[10:11] offset:3040
    s_mov_b64 exec, -1
    s_setprio 0
    s_cmp_le_u32 s18, 3
    s_cbranch_scc1 gem_acc_kernel_P_xs3
    s_waitcnt lgkmcnt(4)
    v_or3_b32 v11, v11, v30, v31
    v_or3_b32 v11, v11, v32, v33
    v_or3_b32 v11, v11, v34, v35
    v_or3_b32 v11, v11, v36, v37
    s_mov_b64 exec, s[34:35]
    v_lshlrev_b32 v118, 16, v80
    v_and_b32 v119, 0xffff0000, v80
    v_lshlrev_b32 v120, 16, v81
    v_and_b32 v121, 0xffff0000, v81
    v_mul_f32 v118, v10, v118
    v_mul_f32 v119, v10, v119
    v_mul_f32 v120, v10, v120
    v_mul_f32 v121, v10, v121
    v_lshlrev_b32 v13, 16, v50
    v_and_b32 v50, 0xffff0000, v50
    v_fmaak_f32 v30, v13, v118, 0x4b400000
    v_fmaak_f32 v31, v50, v118, 0x4b400000
    v_lshl_add_u64 v[30:31], v[30:31], 0, s[16:17]
    ds_add_rtn_u64 v[30:31], v76, v[30:31] offset:65528
    v_lshlrev_b32 v13, 16, v51
    v_and_b32 v51, 0xffff0000, v51
    v_fmaak_f32 v32, v13, v119, 0x4b400000
    v_fmaak_f32 v33, v51, v119, 0x4b400000
    v_lshl_add_u64 v[32:33], v[32:33], 0, s[16:17]
    ds_add_rtn_u64 v[32:33], v77, v[32:33] offset:65528
    v_lshlrev_b32 v13, 16, v52
    v_and_b32 v52, 0xffff0000, v52
    v_fmaak_f32 v34, v13, v120, 0x4b400000
    v_fmaak_f32 v35, v52, v120, 0x4b400000
    v_lshl_add_u64 v[34:35], v[34:35], 0, s[16:17]
    ds_add_rtn_u64 v[34:35], v78, v[34:35] offset:65528
    v_lshlrev_b32 v13, 16, v53
    v_and_b32 v53, 0xffff0000, v53
    v_fmaak_f32 v36, v13, v121, 0x4b400000
    v_fmaak_f32 v37, v53, v121, 0x4b400000
    v_lshl_add_u64 v[36:37], v[36:37], 0, s[16:17]
    ds_add_rtn_u64 v[36:37], v79, v[36:37] offset:65528
    s_mov_b64 exec, -1
gem_acc_kernel_P_xs3:
    s_cmp_le_u32 s18, 4
    s_cbranch_scc1 gem_acc_kernel_P_xs4
    s_waitcnt lgkmcnt(4)
    v_or3_b32 v11, v11, v22, v23
    v_or3_b32 v11, v11, v24, v25
    v_or3_b32 v11, v11, v26, v27
    v_or3_b32 v11, v11, v28, v29
    s_mov_b64 exec, s[36:37]
    v_lshlrev_b32 v118, 16, v86
    v_and_b32 v119, 0xffff0000, v86
    v_lshlrev_b32 v120, 16, v87
    v_and_b32 v121, 0xffff0000, v87
    v_mul_f32 v118, v10, v118
    v_mul_f32 v119, v10, v119
    v_mul_f32 v120, v10, v120
    v_mul_f32 v121, v10, v121
    v_lshlrev_b32 v13, 16, v54
    v_and_b32 v54, 0xffff0000, v54
    v_fmaak_f32 v22, v13, v118, 0x4b400000
    v_fmaak_f32 v23, v54, v118, 0x4b400000
    v_lshl_add_u64 v[22:23], v[22:23], 0, s[16:17]
    ds_add_rtn_u64 v[22:23], v82, v[22:23] offset:65528
    v_lshlrev_b32 v13, 16, v55
    v_and_b32 v55, 0xffff0000, v55
    v_fmaak_f32 v24, v13, v119, 0x4b400000
    v_fmaak_f32 v25, v55, v119, 0x4b400000
    v_lshl_add_u64 v[24:25], v[24:25], 0, s[16:17]
    ds_add_rtn_u64 v[24:25], v83, v[24:25] offset:65528
    v_lshlrev_b32 v13, 16, v56
    v_and_b32 v56, 0xffff0000, v56
    v_fmaak_f32 v26, v13, v120, 0x4b400000
    v_fmaak_f32 v27, v56, v120, 0x4b400000
    v_lshl_add_u64 v[26:27], v[26:27], 0, s[16:17]
    ds_add_rtn_u64 v[26:27], v84, v[26:27] offset:65528
    v_lshlrev_b32 v13, 16, v57
    v_and_b32 v57, 0xffff0000, v57
    v_fmaak_f32 v28, v13, v121, 0x4b400000
    v_fmaak_f32 v29, v57, v121, 0x4b400000
    v_lshl_add_u64 v[28:29], v[28:29], 0, s[16:17]
    ds_add_rtn_u64 v[28:29], v85, v[28:29] offset:65528
    s_mov_b64 exec, -1
gem_acc_kernel_P_xs4:
    s_cmp_eq_u32 s19, 0
    s_cbranch_scc1 gem_acc_kernel_P_cont
    s_cmp_eq_u32 s20, 4
    s_cbranch_scc1 gem_acc_kernel_out
gem_acc_kernel_P_cont:
gem_acc_kernel_bodyB:
    s_mov_b32 s21, s19
    s_mov_b32 s18, s22
    s_mov_b32 s19, s23
    s_mov_b32 s20, s24
    s_mov_b32 s22, s25
    s_mov_b32 s23, s26
    s_mov_b32 s24, s27
    s_mov_b32 s85, s78
    s_mov_b32 s25, s81
    s_mov_b32 s26, s82
    s_mov_b32 s27, s83
    s_mov_b32 s78, s84
    s_waitcnt vmcnt(6)
    s_cmp_eq_u32 s21, 0
    s_cbranch_scc1 gem_acc_kernel_B_noB
    s_barrier
gem_acc_kernel_B_noB:
    s_setprio 3
    s_mov_b64 exec, s[38:39]
    v_and_b32 v13, 0xffff, v88
    ds_read_b32 v38, v13
    v_lshrrev_b32 v88, 13, v88
    v_and_b32 v88, 0x1fff8, v88
    v_and_b32 v15, 0xffff, v89
    ds_read_b32 v39, v15
    v_lshrrev_b32 v89, 13, v89
    v_and_b32 v89, 0x1fff8, v89
    v_and_b32 v13, 0xffff, v90
    ds_read_b32 v40, v13
    v_lshrrev_b32 v90, 13, v90
    v_and_b32 v90, 0x1fff8, v90
    v_and_b32 v15, 0xffff, v91
    ds_read_b32 v41, v15
    v_lshrrev_b32 v91, 13, v91
    v_and_b32 v91, 0x1fff8, v91
    s_mov_b64 exec, -1
    s_setprio 2
    s_mov_b64 exec, s[40:41]
    v_and_b32 v13, 0xffff, v94
    ds_read_b32 v42, v13
    v_lshrrev_b32 v94, 13, v94
    v_and_b32 v94, 0x1fff8, v94
    v_and_b32 v15, 0xffff, v95
    ds_read_b32 v43, v15
    v_lshrrev_b32 v95, 13, v95
    v_and_b32 v95, 0x1fff8, v95
    v_and_b32 v13, 0xffff, v96
    ds_read_b32 v44, v13
    v_lshrrev_b32 v96, 13, v96
    v_and_b32 v96, 0x1fff8, v96
    v_and_b32 v15, 0xffff, v97
    ds_read_b32 v45, v15
    v_lshrrev_b32 v97, 13, v97
    v_and_b32 v97, 0x1fff8, v97
    s_mov_b64 exec, -1
    s_sub_i32 s50, s85, 189
    s_min_i32 s50, s50, 63
    s_max_i32 s50, s50, 1
    s_bfm_b64 s[34:35], s50, 0
    s_mov_b64 exec, s[34:35]
    global_load_dwordx4 v[76:79], v19, s[10:11] offset:0
    global_load_dwordx2 v[80:81], v19, s[10:11] offset:16
    s_mov_b64 exec, -1
    s_setprio 1
    s_mov_b64 exec, s[42:43]
    v_and_b32 v13, 0xffff, v100
    ds_read_b32 v46, v13
    v_lshrrev_b32 v100, 13, v100
    v_and_b32 v100, 0x1fff8, v100
    v_and_b32 v15, 0xffff, v101
    ds_read_b32 v47, v15
    v_lshrrev_b32 v101, 13, v101
    v_and_b32 v101, 0x1fff8, v101
    v_and_b32 v13, 0xffff, v102
    ds_read_b32 v48, v13
    v_lshrrev_b32 v102, 13, v102
    v_and_b32 v102, 0x1fff8, v102
    v_and_b32 v15, 0xffff, v103
    ds_read_b32 v49, v15
    v_lshrrev_b32 v103, 13, v103
    v_and_b32 v103, 0x1fff8, v103
    s_mov_b64 exec, -1
    s_setprio 0
    s_mov_b64 exec, s[44:45]
    v_and_b32 v13, 0xffff, v106
    ds_read_b32 v50, v13
    v_lshrrev_b32 v106, 13, v106
    v_and_b32 v106, 0x1fff8, v106
    v_and_b32 v15, 0xffff, v107
    ds_read_b32 v51, v15
    v_lshrrev_b32 v107, 13, v107
    v_and_b32 v107, 0x1fff8, v107
    v_and_b32 v13, 0xffff, v108
    ds_read_b32 v52, v13
    v_lshrrev_b32 v108, 13, v108
    v_and_b32 v108, 0x1fff8, v108
    v_and_b32 v15, 0xffff, v109
    ds_read_b32 v53, v15
    v_lshrrev_b32 v109, 13, v109
    v_and_b32 v109, 0x1fff8, v109
    s_mov_b64 exec, -1
    s_sub_i32 s50, s85, 252
    s_min_i32 s50, s50, 63
    s_max_i32 s50, s50, 1
    s_bfm_b64 s[36:37], s50, 0
    s_mov_b64 exec, s[36:37]
    global_load_dwordx4 v[82:85], v20, s[10:11] offset:1512
    global_load_dwordx2 v[86:87], v20, s[10:11] offset:1528
    s_mov_b64 exec, -1
    s_mov_b64 exec, s[46:47]
    v_and_b32 v13, 0xffff, v112
    ds_read_b32 v54, v13
    v_lshrrev_b32 v112, 13, v112
    v_and_b32 v112, 0x1fff8, v112
    v_and_b32 v15, 0xffff, v113
    ds_read_b32 v55, v15
    v_lshrrev_b32 v113, 13, v113
    v_and_b32 v113, 0x1fff8, v113
    v_and_b32 v13, 0xffff, v114
    ds_read_b32 v56, v13
    v_lshrrev_b32 v114, 13, v114
    v_and_b32 v114, 0x1fff8, v114
    v_and_b32 v15, 0xffff, v115
    ds_read_b32 v57, v15
    v_lshrrev_b32 v115, 13, v115
    v_and_b32 v115, 0x1fff8, v115
    s_mov_b64 exec, -1
    s_cmp_eq_u32 s82, 0
    s_cbranch_scc1 gem_acc_kernel_B_adv_same
    s_add_u32 s83, s83, 1
    s_cmp_ge_u32 s83, 5
    s_cbranch_scc1 gem_acc_kernel_B_adv_none
    v_and_b32 v13, 0xffff, v3
    v_lshrrev_b32 v15, 16, v3
    v_mov_b32 v3, v4
    v_mov_b32 v4, v5
    v_mov_b32 v5, v0
    v_mov_b32 v0, v127
    v_sub_u32 v15, v15, v13
    v_mov_b32 v21, v15
    s_nop 1
    v_add_u32_dpp v21, v21, v21 row_shr:1 row_mask:0xf bank_mask:0xf
    s_nop 1
    v_add_u32_dpp v21, v21, v21 row_shr:2 row_mask:0xf bank_mask:0xf
    s_nop 1
    v_add_u32_dpp v21, v21, v21 row_shr:4 row_mask:0xf bank_mask:0xf
    s_nop 1
    v_add_u32_dpp v21, v21, v21 row_shr:8 row_mask:0xf bank_mask:0xf
    s_nop 1
    v_add_u32_dpp v21, v21, v21 row_bcast:15 row_mask:0xa bank_mask:0xf
    s_nop 1
    v_add_u32_dpp v21, v21, v21 row_bcast:31 row_mask:0xc bank_mask:0xf
    s_nop 1
    v_readlane_b32 s79, v21, 63
    v_sub_u32 v21, v21, v15
    v_add_u32 v15, -1, v15
    v_and_b32 v15, 0x40000000, v15
    v_lshl_or_b32 v6, v21, 2, v15
    v_sub_u32 v13, v13, v21
    v_mad_i32_i24 v7, v13, 24, v2
    v_mov_b32 v8, v1
    s_mov_b32 s80, 0
    s_branch gem_acc_kernel_B_adv_same
gem_acc_kernel_B_adv_none:
    s_mov_b32 s83, 5
    s_mov_b32 s79, 0
gem_acc_kernel_B_adv_same:
    s_min_u32 s84, s79, 315
    s_sub_u32 s79, s79, s84
    s_cmp_eq_u32 s79, 0
    s_cselect_b32 s82, 1, 0
    s_add_u32 s49, s84, 62
    s_mul_hi_u32 s81, s49, 68174085
    v_min_u32 v16, 252, v6
    v_add_u32 v6, -252, v6
    ds_permute_b32 v16, v16, v7
    v_min_u32 v17, 252, v6
    v_add_u32 v6, -252, v6
    ds_permute_b32 v17, v17, v7
    v_min_u32 v18, 252, v6
    v_add_u32 v6, -252, v6
    ds_permute_b32 v18, v18, v7
    v_min_u32 v19, 252, v6
    v_add_u32 v6, -252, v6
    ds_permute_b32 v19, v19, v7
    v_min_u32 v20, 252, v6
    v_add_u32 v6, -252, v6
    ds_permute_b32 v20, v20, v7
    s_setprio 3
    s_waitcnt lgkmcnt(5)
    s_cmp_eq_u32 s19, 0
    s_cbranch_scc1 gem_acc_kernel_B_x
    s_barrier
    s_add_u32 s48, s20, 1
    s_cmp_ge_u32 s48, 5
    s_cbranch_scc1 gem_acc_kernel_B_x
    global_load_lds_dwordx4 v12, s[12:13] offset:0
    global_load_lds_dwordx4 v12, s[12:13] offset:1024
    global_load_lds_dwordx4 v12, s[12:13] offset:2048
    global_load_lds_dwordx4 v12, s[12:13] offset:3072
    s_add_u32 s12, s12, 64000
    s_addc_u32 s13, s13, 0
gem_acc_kernel_B_x:
    s_cmp_le_u32 s18, 0
    s_cbranch_scc1 gem_acc_kernel_B_xs0
    v_or3_b32 v11, v11, v30, v31
    v_or3_b32 v11, v11, v32, v33
    v_or3_b32 v11, v11, v34, v35
    v_or3_b32 v11, v11, v36, v37
    s_mov_b64 exec, s[38:39]
    v_lshlrev_b32 v118, 16, v92
    v_and_b32 v119, 0xffff0000, v92
    v_lshlrev_b32 v120, 16, v93
    v_and_b32 v121, 0xffff0000, v93
    v_mul_f32 v118, v10, v118
    v_mul_f32 v119, v10, v119
    v_mul_f32 v120, v10, v120
    v_mul_f32 v121, v10, v121
    v_lshlrev_b32 v13, 16, v38
    v_and_b32 v38, 0xffff0000, v38
    v_fmaak_f32 v30, v13, v118, 0x4b400000
    v_fmaak_f32 v31, v38, v118, 0x4b400000
    v_lshl_add_u64 v[30:31], v[30:31], 0, s[16:17]
    ds_add_rtn_u64 v[30:31], v88, v[30:31] offset:65528
    v_lshlrev_b32 v13, 16, v39
    v_and_b32 v39, 0xffff0000, v39
    v_fmaak_f32 v32, v13, v119, 0x4b400000
    v_fmaak_f32 v33, v39, v119, 0x4b400000
    v_lshl_add_u64 v[32:33], v[32:33], 0, s[16:17]
    ds_add_rtn_u64 v[32:33], v89, v[32:33] offset:65528
    v_lshlrev_b32 v13, 16, v40
    v_and_b32 v40, 0xffff0000, v40
    v_fmaak_f32 v34, v13, v120, 0x4b400000
    v_fmaak_f32 v35, v40, v120, 0x4b400000
    v_lshl_add_u64 v[34:35], v[34:35], 0, s[16:17]
    ds_add_rtn_u64 v[34:35], v90, v[34:35] offset:65528
    v_lshlrev_b32 v13, 16, v41
    v_and_b32 v41, 0xffff0000, v41
    v_fmaak_f32 v36, v13, v121, 0x4b400000
    v_fmaak_f32 v37, v41, v121, 0x4b400000
    v_lshl_add_u64 v[36:37], v[36:37], 0, s[16:17]
    ds_add_rtn_u64 v[36:37], v91, v[36:37] offset:65528
    s_mov_b64 exec, -1
gem_acc_kernel_B_xs0:
    s_cmp_gt_u32 s18, 0
    s_cbranch_scc1 L_wo_11_f
    s_waitcnt lgkmcnt(0)
    s_branch L_wo_11_d
L_wo_11_f:
    s_waitcnt lgkmcnt(4)
L_wo_11_d:
    v_add_u32 v9, 4536, v8
    s_nop 1
    v_max_u32_dpp v16, v16, v16 row_shr:1 row_mask:0xf bank_mask:0xf
    v_max_u32_dpp v17, v17, v17 row_shr:1 row_mask:0xf bank_mask:0xf
    v_max_u32_dpp v18, v18, v18 row_shr:1 row_mask:0xf bank_mask:0xf
    v_max_u32_dpp v19, v19, v19 row_shr:1 row_mask:0xf bank_mask:0xf
    v_max_u32_dpp v20, v20, v20 row_shr:1 row_mask:0xf bank_mask:0xf
    v_max_u32_dpp v16, v16, v16 row_shr:2 row_mask:0xf bank_mask:0xf
    v_max_u32_dpp v17, v17, v17 row_shr:2 row_mask:0xf bank_mask:0xf
    v_max_u32_dpp v18, v18, v18 row_shr:2 row_mask:0xf bank_mask:0xf
    v_max_u32_dpp v19, v19, v19 row_shr:2 row_mask:0xf bank_mask:0xf
    v_max_u32_dpp v20, v20, v20 row_shr:2 row_mask:0xf bank_mask:0xf
    s_nop 1
    v_max_u32_dpp v16, v16, v16 row_shr:4 row_mask:0xf bank_mask:0xf
    v_max_u32_dpp v17, v17, v17 row_shr:4 row_mask:0xf bank_mask:0xf
    v_max_u32_dpp v18, v18, v18 row_shr:4 row_mask:0xf bank_mask:0xf
    v_max_u32_dpp v19, v19, v19 row_shr:4 row_mask:0xf bank_mask:0xf
    v_max_u32_dpp v20, v20, v20 row_shr:4 row_mask:0xf bank_mask:0xf
    v_max_u32_dpp v16, v16, v16 row_shr:8 row_mask:0xf bank_mask:0xf
    v_max_u32_dpp v17, v17, v17 row_shr:8 row_mask:0xf bank_mask:0xf
    v_max_u32_dpp v18, v18, v18 row_shr:8 row_mask:0xf bank_mask:0xf
    v_max_u32_dpp v19, v19, v19 row_shr:8 row_mask:0xf bank_mask:0xf
    v_max_u32_dpp v20, v20, v20 row_shr:8 row_mask:0xf bank_mask:0xf
    s_setprio 2
    s_cmp_le_u32 s18, 1
    s_cbranch_scc1 gem_acc_kernel_B_xs1
    v_or3_b32 v11, v11, v22, v23
    v_or3_b32 v11, v11, v24, v25
    v_or3_b32 v11, v11, v26, v27
    v_or3_b32 v11, v11, v28, v29
    s_mov_b64 exec, s[40:41]
    v_lshlrev_b32 v118, 16, v98
    v_and_b32 v119, 0xffff0000, v98
    v_lshlrev_b32 v120, 16, v99
    v_and_b32 v121, 0xffff0000, v99
    v_mul_f32 v118, v10, v118
    v_mul_f32 v119, v10, v119
    v_mul_f32 v120, v10, v120
    v_mul_f32 v121, v10, v121
    v_lshlrev_b32 v13, 16, v42
    v_and_b32 v42, 0xffff0000, v42
    v_fmaak_f32 v22, v13, v118, 0x4b400000
    v_fmaak_f32 v23, v42, v118, 0x4b400000
    v_lshl_add_u64 v[22:23], v[22:23], 0, s[16:17]
    ds_add_rtn_u64 v[22:23], v94, v[22:23] offset:65528
    v_lshlrev_b32 v13, 16, v43
    v_and_b32 v43, 0xffff0000, v43
    v_fmaak_f32 v24, v13, v119, 0x4b400000
    v_fmaak_f32 v25, v43, v119, 0x4b400000
    v_lshl_add_u64 v[24:25], v[24:25], 0, s[16:17]
    ds_add_rtn_u64 v[24:25], v95, v[24:25] offset:65528
    v_lshlrev_b32 v13, 16, v44
    v_and_b32 v44, 0xffff0000, v44
    v_fmaak_f32 v26, v13, v120, 0x4b400000
    v_fmaak_f32 v27, v44, v120, 0x4b400000
    v_lshl_add_u64 v[26:27], v[26:27], 0, s[16:17]
    ds_add_rtn_u64 v[26:27], v96, v[26:27] offset:65528
    v_lshlrev_b32 v13, 16, v45
    v_and_b32 v45, 0xffff0000, v45
    v_fmaak_f32 v28, v13, v121, 0x4b400000
    v_fmaak_f32 v29, v45, v121, 0x4b400000
    v_lshl_add_u64 v[28:29], v[28:29], 0, s[16:17]
    ds_add_rtn_u64 v[28:29], v97, v[28:29] offset:65528
    s_mov_b64 exec, -1
gem_acc_kernel_B_xs1:
    s_nop 1
    v_max_u32_dpp v16, v16, v16 row_bcast:15 row_mask:0xa bank_mask:0xf
    v_max_u32_dpp v17, v17, v17 row_bcast:15 row_mask:0xa bank_mask:0xf
    v_max_u32_dpp v18, v18, v18 row_bcast:15 row_mask:0xa bank_mask:0xf
    v_max_u32_dpp v19, v19, v19 row_bcast:15 row_mask:0xa bank_mask:0xf
    v_max_u32_dpp v20, v20, v20 row_bcast:15 row_mask:0xa bank_mask:0xf
    v_max_u32_dpp v16, v16, v16 row_bcast:31 row_mask:0xc bank_mask:0xf
    v_max_u32_dpp v17, v17, v17 row_bcast:31 row_mask:0xc bank_mask:0xf
    v_max_u32_dpp v18, v18, v18 row_bcast:31 row_mask:0xc bank_mask:0xf
    v_max_u32_dpp v19, v19, v19 row_bcast:31 row_mask:0xc bank_mask:0xf
    v_max_u32_dpp v20, v20, v20 row_bcast:31 row_mask:0xc bank_mask:0xf
    v_readlane_b32 s60, v16, 62
    v_readlane_b32 s61, v17, 62
    v_readlane_b32 s62, v18, 62
    v_readlane_b32 s63, v19, 62
    v_readlane_b32 s64, v20, 62
    s_nop 1
    s_sub_i32 s50, s78, 0
    s_min_i32 s50, s50, 63
    s_max_i32 s50, s50, 1
    s_bfm_b64 s[38:39], s50, 0
    s_mov_b64 exec, s[38:39]
    global_load_dwordx4 v[88:91], v122, s[10:11] offset:0
    global_load_dwordx2 v[92:93], v122, s[10:11] offset:16
    s_mov_b64 exec, -1
    s_setprio 1
    s_cmp_le_u32 s18, 2
    s_cbranch_scc1 gem_acc_kernel_B_xs2
    s_waitcnt lgkmcnt(4)
    v_or3_b32 v11, v11, v30, v31
    v_or3_b32 v11, v11, v32, v33
    v_or3_b32 v11, v11, v34, v35
    v_or3_b32 v11, v11, v36, v37
    s_mov_b64 exec, s[42:43]
    v_lshlrev_b32 v118, 16, v104
    v_and_b32 v119, 0xffff0000, v104
    v_lshlrev_b32 v120, 16, v105
    v_and_b32 v121, 0xffff0000, v105
    v_mul_f32 v118, v10, v118
    v_mul_f32 v119, v10, v119
    v_mul_f32 v120, v10, v120
    v_mul_f32 v121, v10, v121
    v_lshlrev_b32 v13, 16, v46
    v_and_b32 v46, 0xffff0000, v46
    v_fmaak_f32 v30, v13, v118, 0x4b400000
    v_fmaak_f32 v31, v46, v118, 0x4b400000
    v_lshl_add_u64 v[30:31], v[30:31], 0, s[16:17]
    ds_add_rtn_u64 v[30:31], v100, v[30:31] offset:65528
    v_lshlrev_b32 v13, 16, v47
    v_and_b32 v47, 0xffff0000, v47
    v_fmaak_f32 v32, v13, v119, 0x4b400000
    v_fmaak_f32 v33, v47, v119, 0x4b400000
    v_lshl_add_u64 v[32:33], v[32:33], 0, s[16:17]
    ds_add_rtn_u64 v[32:33], v101, v[32:33] offset:65528
    v_lshlrev_b32 v13, 16, v48
    v_and_b32 v48, 0xffff0000, v48
    v_fmaak_f32 v34, v13, v120, 0x4b400000
    v_fmaak_f32 v35, v48, v120, 0x4b400000
    v_lshl_add_u64 v[34:35], v[34:35], 0, s[16:17]
    ds_add_rtn_u64 v[34:35], v102, v[34:35] offset:65528
    v_lshlrev_b32 v13, 16, v49
    v_and_b32 v49, 0xffff0000, v49
    v_fmaak_f32 v36, v13, v121, 0x4b400000
    v_fmaak_f32 v37, v49, v121, 0x4b400000
    v_lshl_add_u64 v[36:37], v[36:37], 0, s[16:17]
    ds_add_rtn_u64 v[36:37], v103, v[36:37] offset:65528
    s_mov_b64 exec, -1
gem_acc_kernel_B_xs2:
    v_max_u32 v16, s80, v16
    s_max_u32 s60, s60, s80
    v_max_u32 v17, s60, v17
    s_max_u32 s61, s61, s60
    v_max_u32 v18, s61, v18
    s_max_u32 s62, s62, s61
    v_max_u32 v19, s62, v19
    s_max_u32 s63, s63, s62
    v_max_u32 v20, s63, v20
    s_max_u32 s64, s64, s63
    s_mov_b32 s80, s64
    v_add_u32 v16, v8, v16
    v_add_u32 v17, v8, v17
    v_add_u32 v18, v8, v18
    v_add_u32 v19, v9, v19
    v_add_u32 v20, v9, v20
    v_add_u32 v8, 7560, v8
    s_sub_i32 s50, s78, 63
    s_min_i32 s50, s50, 63
    s_max_i32 s50, s50, 1
    s_bfm_b64 s[40:41], s50, 0
    s_mov_b64 exec, s[40:41]
    global_load_dwordx4 v[94:97], v123, s[10:11] offset:1512
    global_load_dwordx2 v[98:99], v123, s[10:11] offset:1528
    s_mov_b64 exec, -1
    s_setprio 0
    s_cmp_le_u32 s18, 3
    s_cbranch_scc1 gem_acc_kernel_B_xs3
    s_waitcnt lgkmcnt(4)
    v_or3_b32 v11, v11, v22, v23
    v_or3_b32 v11, v11, v24, v25
    v_or3_b32 v11, v11, v26, v27
    v_or3_b32 v11, v11, v28, v29
    s_mov_b64 exec, s[44:45]
    v_lshlrev_b32 v118, 16, v110
    v_and_b32 v119, 0xffff0000, v110
    v_lshlrev_b32 v120, 16, v111
    v_and_b32 v121, 0xffff0000, v111
    v_mul_f32 v118, v10, v118
    v_mul_f32 v119, v10, v119
    v_mul_f32 v120, v10, v120
    v_mul_f32 v121, v10, v121
    v_lshlrev_b32 v13, 16, v50
    v_and_b32 v50, 0xffff0000, v50
    v_fmaak_f32 v22, v13, v118, 0x4b400000
    v_fmaak_f32 v23, v50, v118, 0x4b400000
    v_lshl_add_u64 v[22:23], v[22:23], 0, s[16:17]
    ds_add_rtn_u64 v[22:23], v106, v[22:23] offset:65528
    v_lshlrev_b32 v13, 16, v51
    v_and_b32 v51, 0xffff0000, v51
    v_fmaak_f32 v24, v13, v119, 0x4b400000
    v_fmaak_f32 v25, v51, v119, 0x4b400000
    v_lshl_add_u64 v[24:25], v[24:25], 0, s[16:17]
    ds_add_rtn_u64 v[24:25], v107, v[24:25] offset:65528
    v_lshlrev_b32 v13, 16, v52
    v_and_b32 v52, 0xffff0000, v52
    v_fmaak_f32 v26, v13, v120, 0x4b400000
    v_fmaak_f32 v27, v52, v120, 0x4b400000
    v_lshl_add_u64 v[26:27], v[26:27], 0, s[16:17]
    ds_add_rtn_u64 v[26:27], v108, v[26:27] offset:65528
    v_lshlrev_b32 v13, 16, v53
    v_and_b32 v53, 0xffff0000, v53
    v_fmaak_f32 v28, v13, v121, 0x4b400000
    v_fmaak_f32 v29, v53, v121, 0x4b400000
    v_lshl_add_u64 v[28:29], v[28:29], 0, s[16:17]
    ds_add_rtn_u64 v[28:29], v109, v[28:29] offset:65528
    s_mov_b64 exec, -1
gem_acc_kernel_B_xs3:
    s_sub_i32 s50, s78, 126
    s_min_i32 s50, s50, 63
    s_max_i32 s50, s50, 1
    s_bfm_b64 s[42:43], s50, 0
    s_mov_b64 exec, s[42:43]
    global_load_dwordx4 v[100:103], v124, s[10:11] offset:3024
    global_load_dwordx2 v[104:105], v124, s[10:11] offset:3040
    s_mov_b64 exec, -1
    s_cmp_le_u32 s18, 4
    s_cbranch_scc1 gem_acc_kernel_B_xs4
    s_waitcnt lgkmcnt(4)
    v_or3_b32 v11, v11, v30, v31
    v_or3_b32 v11, v11, v32, v33
    v_or3_b32 v11, v11, v34, v35
    v_or3_b32 v11, v11, v36, v37
    s_mov_b64 exec, s[46:47]
    v_lshlrev_b32 v118, 16, v116
    v_and_b32 v119, 0xffff0000, v116
    v_lshlrev_b32 v120, 16, v117
    v_and_b32 v121, 0xffff0000, v117
    v_mul_f32 v118, v10, v118
    v_mul_f32 v119, v10, v119
    v_mul_f32 v120, v10, v120
    v_mul_f32 v121, v10, v121
    v_lshlrev_b32 v13, 16, v54
    v_and_b32 v54, 0xffff0000, v54
    v_fmaak_f32 v30, v13, v118, 0x4b400000
    v_fmaak_f32 v31, v54, v118, 0x4b400000
    v_lshl_add_u64 v[30:31], v[30:31], 0, s[16:17]
    ds_add_rtn_u64 v[30:31], v112, v[30:31] offset:65528
    v_lshlrev_b32 v13, 16, v55
    v_and_b32 v55, 0xffff0000, v55
    v_fmaak_f32 v32, v13, v119, 0x4b400000
    v_fmaak_f32 v33, v55, v119, 0x4b400000
    v_lshl_add_u64 v[32:33], v[32:33], 0, s[16:17]
    ds_add_rtn_u64 v[32:33], v113, v[32:33] offset:65528
    v_lshlrev_b32 v13, 16, v56
    v_and_b32 v56, 0xffff0000, v56
    v_fmaak_f32 v34, v13, v120, 0x4b400000
    v_fmaak_f32 v35, v56, v120, 0x4b400000
    v_lshl_add_u64 v[34:35], v[34:35], 0, s[16:17]
    ds_add_rtn_u64 v[34:35], v114, v[34:35] offset:65528
    v_lshlrev_b32 v13, 16, v57
    v_and_b32 v57, 0xffff0000, v57
    v_fmaak_f32 v36, v13, v121, 0x4b400000
    v_fmaak_f32 v37, v57, v121, 0x4b400000
    v_lshl_add_u64 v[36:37], v[36:37], 0, s[16:17]
    ds_add_rtn_u64 v[36:37], v115, v[36:37] offset:65528
    s_mov_b64 exec, -1
gem_acc_kernel_B_xs4:
    s_cmp_eq_u32 s19, 0
    s_cbranch_scc1 gem_acc_kernel_B_cont
    s_cmp_eq_u32 s20, 4
    s_cbranch_scc1 gem_acc_kernel_out
gem_acc_kernel_B_cont:
    s_mov_b32 s21, s19
    s_mov_b32 s18, s22
    s_mov_b32 s19, s23
    s_mov_b32 s20, s24
    s_mov_b32 s22, s25
    s_mov_b32 s23, s26
    s_mov_b32 s24, s27
    s_mov_b32 s85, s78
    s_mov_b32 s25, s81
    s_mov_b32 s26, s82
    s_mov_b32 s27, s83
    s_mov_b32 s78, s84
    s_waitcnt vmcnt(6)
    s_cmp_eq_u32 s21, 0
    s_cbranch_scc1 gem_acc_kernel_A_noB
    s_barrier
gem_acc_kernel_A_noB:
    s_setprio 3
    s_mov_b64 exec, s[28:29]
    v_and_b32 v13, 0xffff, v58
    ds_read_b32 v38, v13
    v_lshrrev_b32 v58, 13, v58
    v_and_b32 v58, 0x1fff8, v58
    v_and_b32 v15, 0xffff, v59
    ds_read_b32 v39, v15
    v_lshrrev_b32 v59, 13, v59
    v_and_b32 v59, 0x1fff8, v59
    v_and_b32 v13, 0xffff, v60
    ds_read_b32 v40, v13
    v_lshrrev_b32 v60, 13, v60
    v_and_b32 v60, 0x1fff8, v60
    v_and_b32 v15, 0xffff, v61
    ds_read_b32 v41, v15
    v_lshrrev_b32 v61, 13, v61
    v_and_b32 v61, 0x1fff8, v61
    s_mov_b64 exec, -1
    s_setprio 2
    s_mov_b64 exec, s[30:31]
    v_and_b32 v13, 0xffff, v64
    ds_read_b32 v42, v13
    v_lshrrev_b32 v64, 13, v64
    v_and_b32 v64, 0x1fff8, v64
    v_and_b32 v15, 0xffff, v65
    ds_read_b32 v43, v15
    v_lshrrev_b32 v65, 13, v65
    v_and_b32 v65, 0x1fff8, v65
    v_and_b32 v13, 0xffff, v66
    ds_read_b32 v44, v13
    v_lshrrev_b32 v66, 13, v66
    v_and_b32 v66, 0x1fff8, v66
    v_and_b32 v15, 0xffff, v67
    ds_read_b32 v45, v15
    v_lshrrev_b32 v67, 13, v67
    v_and_b32 v67, 0x1fff8, v67
    s_mov_b64 exec, -1
    s_sub_i32 s50, s85, 189
    s_min_i32 s50, s50, 63
    s_max_i32 s50, s50, 1
    s_bfm_b64 s[44:45], s50, 0
    s_mov_b64 exec, s[44:45]
    global_load_dwordx4 v[106:109], v125, s[10:11] offset:0
    global_load_dwordx2 v[110:111], v125, s[10:11] offset:16
    s_mov_b64 exec, -1
    s_setprio 1
    s_mov_b64 exec, s[32:33]
    v_and_b32 v13, 0xffff, v70
    ds_read_b32 v46, v13
    v_lshrrev_b32 v70, 13, v70
    v_and_b32 v70, 0x1fff8, v70
    v_and_b32 v15, 0xffff, v71
    ds_read_b32 v47, v15
    v_lshrrev_b32 v71, 13, v71
    v_and_b32 v71, 0x1fff8, v71
    v_and_b32 v13, 0xffff, v72
    ds_read_b32 v48, v13
    v_lshrrev_b32 v72, 13, v72
    v_and_b32 v72, 0x1fff8, v72
    v_and_b32 v15, 0xffff, v73
    ds_read_b32 v49, v15
    v_lshrrev_b32 v73, 13, v73
    v_and_b32 v73, 0x1fff8, v73
    s_mov_b64 exec, -1
    s_setprio 0
    s_mov_b64 exec, s[34:35]
    v_and_b32 v13, 0xffff, v76
    ds_read_b32 v50, v13
    v_lshrrev_b32 v76, 13, v76
    v_and_b32 v76, 0x1fff8, v76
    v_and_b32 v15, 0xffff, v77
    ds_read_b32 v51, v15
    v_lshrrev_b32 v77, 13, v77
    v_and_b32 v77, 0x1fff8, v77
    v_and_b32 v13, 0xffff, v78
    ds_read_b32 v52, v13
    v_lshrrev_b32 v78, 13, v78
    v_and_b32 v78, 0x1fff8, v78
    v_and_b32 v15, 0xffff, v79
    ds_read_b32 v53, v15
    v_lshrrev_b32 v79, 13, v79
    v_and_b32 v79, 0x1fff8, v79
    s_mov_b64 exec, -1
    s_sub_i32 s50, s85, 252
    s_min_i32 s50, s50, 63
    s_max_i32 s50, s50, 1
    s_bfm_b64 s[46:47], s50, 0
    s_mov_b64 exec, s[46:47]
    global_load_dwordx4 v[112:115], v126, s[10:11] offset:1512
    global_load_dwordx2 v[116:117], v126, s[10:11] offset:1528
    s_mov_b64 exec, -1
    s_mov_b64 exec, s[36:37]
    v_and_b32 v13, 0xffff, v82
    ds_read_b32 v54, v13
    v_lshrrev_b32 v82, 13, v82
    v_and_b32 v82, 0x1fff8, v82
    v_and_b32 v15, 0xffff, v83
    ds_read_b32 v55, v15
    v_lshrrev_b32 v83, 13, v83
    v_and_b32 v83, 0x1fff8, v83
    v_and_b32 v13, 0xffff, v84
    ds_read_b32 v56, v13
    v_lshrrev_b32 v84, 13, v84
    v_and_b32 v84, 0x1fff8, v84
    v_and_b32 v15, 0xffff, v85
    ds_read_b32 v57, v15
    v_lshrrev_b32 v85, 13, v85
    v_and_b32 v85, 0x1fff8, v85
    s_mov_b64 exec, -1
    s_cmp_eq_u32 s82, 0
    s_cbranch_scc1 gem_acc_kernel_A_adv_same
    s_add_u32 s83, s83, 1
    s_cmp_ge_u32 s83, 5
    s_cbranch_scc1 gem_acc_kernel_A_adv_none
    v_and_b32 v13, 0xffff, v3
    v_lshrrev_b32 v15, 16, v3
    v_mov_b32 v3, v4
    v_mov_b32 v4, v5
    v_mov_b32 v5, v0
    v_mov_b32 v0, v127
    v_sub_u32 v15, v15, v13
    v_mov_b32 v21, v15
    s_nop 1
    v_add_u32_dpp v21, v21, v21 row_shr:1 row_mask:0xf bank_mask:0xf
    s_nop 1
    v_add_u32_dpp v21, v21, v21 row_shr:2 row_mask:0xf bank_mask:0xf
    s_nop 1
    v_add_u32_dpp v21, v21, v21 row_shr:4 row_mask:0xf bank_mask:0xf
    s_nop 1
    v_add_u32_dpp v21, v21, v21 row_shr:8 row_mask:0xf bank_mask:0xf
    s_nop 1
    v_add_u32_dpp v21, v21, v21 row_bcast:15 row_mask:0xa bank_mask:0xf
    s_nop 1
    v_add_u32_dpp v21, v21, v21 row_bcast:31 row_mask:0xc bank_mask:0xf
    s_nop 1
    v_readlane_b32 s79, v21, 63
    v_sub_u32 v21, v21, v15
    v_add_u32 v15, -1, v15
    v_and_b32 v15, 0x40000000, v15
    v_lshl_or_b32 v6, v21, 2, v15
    v_sub_u32 v13, v13, v21
    v_mad_i32_i24 v7, v13, 24, v2
    v_mov_b32 v8, v1
    s_mov_b32 s80, 0
    s_branch gem_acc_kernel_A_adv_same
gem_acc_kernel_A_adv_none:
    s_mov_b32 s83, 5
    s_mov_b32 s79, 0
gem_acc_kernel_A_adv_same:
    s_min_u32 s84, s79, 315
    s_sub_u32 s79, s79, s84
    s_cmp_eq_u32 s79, 0
    s_cselect_b32 s82, 1, 0
    s_add_u32 s49, s84, 62
    s_mul_hi_u32 s81, s49, 68174085
    v_min_u32 v122, 252, v6
    v_add_u32 v6, -252, v6
    ds_permute_b32 v122, v122, v7
    v_min_u32 v123, 252, v6
    v_add_u32 v6, -252, v6
    ds_permute_b32 v123, v123, v7
    v_min_u32 v124, 252, v6
    v_add_u32 v6, -252, v6
    ds_permute_b32 v124, v124, v7
    v_min_u32 v125, 252, v6
    v_add_u32 v6, -252, v6
    ds_permute_b32 v125, v125, v7
    v_min_u32 v126, 252, v6
    v_add_u32 v6, -252, v6
    ds_permute_b32 v126, v126, v7
    s_setprio 3
    s_waitcnt lgkmcnt(5)
    s_cmp_eq_u32 s19, 0
    s_cbranch_scc1 gem_acc_kernel_A_x
    s_barrier
    s_add_u32 s48, s20, 1
    s_cmp_ge_u32 s48, 5
    s_cbranch_scc1 gem_acc_kernel_A_x
    global_load_lds_dwordx4 v12, s[12:13] offset:0
    global_load_lds_dwordx4 v12, s[12:13] offset:1024
    global_load_lds_dwordx4 v12, s[12:13] offset:2048
    global_load_lds_dwordx4 v12, s[12:13] offset:3072
    s_add_u32 s12, s12, 64000
    s_addc_u32 s13, s13, 0
gem_acc_kernel_A_x:
    s_cmp_le_u32 s18, 0
    s_cbranch_scc1 gem_acc_kernel_A_xs0
    v_or3_b32 v11, v11, v22, v23
    v_or3_b32 v11, v11, v24, v25
    v_or3_b32 v11, v11, v26, v27
    v_or3_b32 v11, v11, v28, v29
    s_mov_b64 exec, s[28:29]
    v_lshlrev_b32 v118, 16, v62
    v_and_b32 v119, 0xffff0000, v62
    v_lshlrev_b32 v120, 16, v63
    v_and_b32 v121, 0xffff0000, v63
    v_mul_f32 v118, v10, v118
    v_mul_f32 v119, v10, v119
    v_mul_f32 v120, v10, v120
    v_mul_f32 v121, v10, v121
    v_lshlrev_b32 v13, 16, v38
    v_and_b32 v38, 0xffff0000, v38
    v_fmaak_f32 v22, v13, v118, 0x4b400000
    v_fmaak_f32 v23, v38, v118, 0x4b400000
    v_lshl_add_u64 v[22:23], v[22:23], 0, s[16:17]
    ds_add_rtn_u64 v[22:23], v58, v[22:23] offset:65528
    v_lshlrev_b32 v13, 16, v39
    v_and_b32 v39, 0xffff0000, v39
    v_fmaak_f32 v24, v13, v119, 0x4b400000
    v_fmaak_f32 v25, v39, v119, 0x4b400000
    v_lshl_add_u64 v[24:25], v[24:25], 0, s[16:17]
    ds_add_rtn_u64 v[24:25], v59, v[24:25] offset:65528
    v_lshlrev_b32 v13, 16, v40
    v_and_b32 v40, 0xffff0000, v40
    v_fmaak_f32 v26, v13, v120, 0x4b400000
    v_fmaak_f32 v27, v40, v120, 0x4b400000
    v_lshl_add_u64 v[26:27], v[26:27], 0, s[16:17]
    ds_add_rtn_u64 v[26:27], v60, v[26:27] offset:65528
    v_lshlrev_b32 v13, 16, v41
    v_and_b32 v41, 0xffff0000, v41
    v_fmaak_f32 v28, v13, v121, 0x4b400000
    v_fmaak_f32 v29, v41, v121, 0x4b400000
    v_lshl_add_u64 v[28:29], v[28:29], 0, s[16:17]
    ds_add_rtn_u64 v[28:29], v61, v[28:29] offset:65528
    s_mov_b64 exec, -1
gem_acc_kernel_A_xs0:
    s_cmp_gt_u32 s18, 0
    s_cbranch_scc1 L_wo_12_f
    s_waitcnt lgkmcnt(0)
    s_branch L_wo_12_d
L_wo_12_f:
    s_waitcnt lgkmcnt(4)
L_wo_12_d:
    v_add_u32 v9, 4536, v8
    s_nop 1
    v_max_u32_dpp v122, v122, v122 row_shr:1 row_mask:0xf bank_mask:0xf
    v_max_u32_dpp v123, v123, v123 row_shr:1 row_mask:0xf bank_mask:0xf
    v_max_u32_dpp v124, v124, v124 row_shr:1 row_mask:0xf bank_mask:0xf
    v_max_u32_dpp v125, v125, v125 row_shr:1 row_mask:0xf bank_mask:0xf
    v_max_u32_dpp v126, v126, v126 row_shr:1 row_mask:0xf bank_mask:0xf
    v_max_u32_dpp v122, v122, v122 row_shr:2 row_mask:0xf bank_mask:0xf
    v_max_u32_dpp v123, v123, v123 row_shr:2 row_mask:0xf bank_mask:0xf
    v_max_u32_dpp v124, v124, v124 row_shr:2 row_mask:0xf bank_mask:0xf
    v_max_u32_dpp v125, v125, v125 row_shr:2 row_mask:0xf bank_mask:0xf
    v_max_u32_dpp v126, v126, v126 row_shr:2 row_mask:0xf bank_mask:0xf
    s_nop 1
    v_max_u32_dpp v122, v122, v122 row_shr:4 row_mask:0xf bank_mask:0xf
    v_max_u32_dpp v123, v123, v123 row_shr:4 row_mask:0xf bank_mask:0xf
    v_max_u32_dpp v124, v124, v124 row_shr:4 row_mask:0xf bank_mask:0xf
    v_max_u32_dpp v125, v125, v125 row_shr:4 row_mask:0xf bank_mask:0xf
    v_max_u32_dpp v126, v126, v126 row_shr:4 row_mask:0xf bank_mask:0xf
    v_max_u32_dpp v122, v122, v122 row_shr:8 row_mask:0xf bank_mask:0xf
    v_max_u32_dpp v123, v123, v123 row_shr:8 row_mask:0xf bank_mask:0xf
    v_max_u32_dpp v124, v124, v124 row_shr:8 row_mask:0xf bank_mask:0xf
    v_max_u32_dpp v125, v125, v125 row_shr:8 row_mask:0xf bank_mask:0xf
    v_max_u32_dpp v126, v126, v126 row_shr:8 row_mask:0xf bank_mask:0xf
    s_setprio 2
    s_cmp_le_u32 s18, 1
    s_cbranch_scc1 gem_acc_kernel_A_xs1
    v_or3_b32 v11, v11, v30, v31
    v_or3_b32 v11, v11, v32, v33
    v_or3_b32 v11, v11, v34, v35
    v_or3_b32 v11, v11, v36, v37
    s_mov_b64 exec, s[30:31]
    v_lshlrev_b32 v118, 16, v68
    v_and_b32 v119, 0xffff0000, v68
    v_lshlrev_b32 v120, 16, v69
    v_and_b32 v121, 0xffff0000, v69
    v_mul_f32 v118, v10, v118
    v_mul_f32 v119, v10, v119
    v_mul_f32 v120, v10, v120
    v_mul_f32 v121, v10, v121
    v_lshlrev_b32 v13, 16, v42
    v_and_b32 v42, 0xffff0000, v42
    v_fmaak_f32 v30, v13, v118, 0x4b400000
    v_fmaak_f32 v31, v42, v118, 0x4b400000
    v_lshl_add_u64 v[30:31], v[30:31], 0, s[16:17]
    ds_add_rtn_u64 v[30:31], v64, v[30:31] offset:65528
    v_lshlrev_b32 v13, 16, v43
    v_and_b32 v43, 0xffff0000, v43
    v_fmaak_f32 v32, v13, v119, 0x4b400000
    v_fmaak_f32 v33, v43, v119, 0x4b400000
    v_lshl_add_u64 v[32:33], v[32:33], 0, s[16:17]
    ds_add_rtn_u64 v[32:33], v65, v[32:33] offset:65528
    v_lshlrev_b32 v13, 16, v44
    v_and_b32 v44, 0xffff0000, v44
    v_fmaak_f32 v34, v13, v120, 0x4b400000
    v_fmaak_f32 v35, v44, v120, 0x4b400000
    v_lshl_add_u64 v[34:35], v[34:35], 0, s[16:17]
    ds_add_rtn_u64 v[34:35], v66, v[34:35] offset:65528
    v_lshlrev_b32 v13, 16, v45
    v_and_b32 v45, 0xffff0000, v45
    v_fmaak_f32 v36, v13, v121, 0x4b400000
    v_fmaak_f32 v37, v45, v121, 0x4b400000
    v_lshl_add_u64 v[36:37], v[36:37], 0, s[16:17]
    ds_add_rtn_u64 v[36:37], v67, v[36:37] offset:65528
    s_mov_b64 exec, -1
gem_acc_kernel_A_xs1:
    s_nop 1
    v_max_u32_dpp v122, v122, v122 row_bcast:15 row_mask:0xa bank_mask:0xf
    v_max_u32_dpp v123, v123, v123 row_bcast:15 row_mask:0xa bank_mask:0xf
    v_max_u32_dpp v124, v124, v124 row_bcast:15 row_mask:0xa bank_mask:0xf
    v_max_u32_dpp v125, v125, v125 row_bcast:15 row_mask:0xa bank_mask:0xf
    v_max_u32_dpp v126, v126, v126 row_bcast:15 row_mask:0xa bank_mask:0xf
    v_max_u32_dpp v122, v122, v122 row_bcast:31 row_mask:0xc bank_mask:0xf
    v_max_u32_dpp v123, v123, v123 row_bcast:31 row_mask:0xc bank_mask:0xf
    v_max_u32_dpp v124, v124, v124 row_bcast:31 row_mask:0xc bank_mask:0xf
    v_max_u32_dpp v125, v125, v125 row_bcast:31 row_mask:0xc bank_mask:0xf
    v_max_u32_dpp v126, v126, v126 row_bcast:31 row_mask:0xc bank_mask:0xf
    v_readlane_b32 s60, v122, 62
    v_readlane_b32 s61, v123, 62
    v_readlane_b32 s62, v124, 62
    v_readlane_b32 s63, v125, 62
    v_readlane_b32 s64, v126, 62
    s_nop 1
    s_sub_i32 s50, s78, 0
    s_min_i32 s50, s50, 63
    s_max_i32 s50, s50, 1
    s_bfm_b64 s[28:29], s50, 0
    s_mov_b64 exec, s[28:29]
    global_load_dwordx4 v[58:61], v16, s[10:11] offset:0
    global_load_dwordx2 v[62:63], v16, s[10:11] offset:16
    s_mov_b64 exec, -1
    s_setprio 1
    s_cmp_le_u32 s18, 2
    s_cbranch_scc1 gem_acc_kernel_A_xs2
    s_waitcnt lgkmcnt(4)
    v_or3_b32 v11, v11, v22, v23
    v_or3_b32 v11, v11, v24, v25
    v_or3_b32 v11, v11, v26, v27
    v_or3_b32 v11, v11, v28, v29
    s_mov_b64 exec, s[32:33]
    v_lshlrev_b32 v118, 16, v74
    v_and_b32 v119, 0xffff0000, v74
    v_lshlrev_b32 v120, 16, v75
    v_and_b32 v121, 0xffff0000, v75
    v_mul_f32 v118, v10, v118
    v_mul_f32 v119, v10, v119
    v_mul_f32 v120, v10, v120
    v_mul_f32 v121, v10, v121
    v_lshlrev_b32 v13, 16, v46
    v_and_b32 v46, 0xffff0000, v46
    v_fmaak_f32 v22, v13, v118, 0x4b400000
    v_fmaak_f32 v23, v46, v118, 0x4b400000
    v_lshl_add_u64 v[22:23], v[22:23], 0, s[16:17]
    ds_add_rtn_u64 v[22:23], v70, v[22:23] offset:65528
    v_lshlrev_b32 v13, 16, v47
    v_and_b32 v47, 0xffff0000, v47
    v_fmaak_f32 v24, v13, v119, 0x4b400000
    v_fmaak_f32 v25, v47, v119, 0x4b400000
    v_lshl_add_u64 v[24:25], v[24:25], 0, s[16:17]
    ds_add_rtn_u64 v[24:25], v71, v[24:25] offset:65528
    v_lshlrev_b32 v13, 16, v48
    v_and_b32 v48, 0xffff0000, v48
    v_fmaak_f32 v26, v13, v120, 0x4b400000
    v_fmaak_f32 v27, v48, v120, 0x4b400000
    v_lshl_add_u64 v[26:27], v[26:27], 0, s[16:17]
    ds_add_rtn_u64 v[26:27], v72, v[26:27] offset:65528
    v_lshlrev_b32 v13, 16, v49
    v_and_b32 v49, 0xffff0000, v49
    v_fmaak_f32 v28, v13, v121, 0x4b400000
    v_fmaak_f32 v29, v49, v121, 0x4b400000
    v_lshl_add_u64 v[28:29], v[28:29], 0, s[16:17]
    ds_add_rtn_u64 v[28:29], v73, v[28:29] offset:65528
    s_mov_b64 exec, -1
gem_acc_kernel_A_xs2:
    v_max_u32 v122, s80, v122
    s_max_u32 s60, s60, s80
    v_max_u32 v123, s60, v123
    s_max_u32 s61, s61, s60
    v_max_u32 v124, s61, v124
    s_max_u32 s62, s62, s61
    v_max_u32 v125, s62, v125
    s_max_u32 s63, s63, s62
    v_max_u32 v126, s63, v126
    s_max_u32 s64, s64, s63
    s_mov_b32 s80, s64
    v_add_u32 v122, v8, v122
    v_add_u32 v123, v8, v123
    v_add_u32 v124, v8, v124
    v_add_u32 v125, v9, v125
    v_add_u32 v126, v9, v126
    v_add_u32 v8, 7560, v8
    s_sub_i32 s50, s78, 63
    s_min_i32 s50, s50, 63
    s_max_i32 s50, s50, 1
    s_bfm_b64 s[30:31], s50, 0
    s_mov_b64 exec, s[30:31]
    global_load_dwordx4 v[64:67], v17, s[10:11] offset:1512
    global_load_dwordx2 v[68:69], v17, s[10:11] offset:1528
    s_mov_b64 exec, -1
    s_setprio 0
    s_cmp_le_u32 s18, 3
    s_cbranch_scc1 gem_acc_kernel_A_xs3
    s_waitcnt lgkmcnt(4)
    v_or3_b32 v11, v11, v30, v31
    v_or3_b32 v11, v11, v32, v33
    v_or3_b32 v11, v11, v34, v35
    v_or3_b32 v11, v11, v36, v37
    s_mov_b64 exec, s[34:35]
    v_lshlrev_b32 v118, 16, v80
    v_and_b32 v119, 0xffff0000, v80
    v_lshlrev_b32 v120, 16, v81
    v_and_b32 v121, 0xffff0000, v81
    v_mul_f32 v118, v10, v118
    v_mul_f32 v119, v10, v119
    v_mul_f32 v120, v10, v120
    v_mul_f32 v121, v10, v121
    v_lshlrev_b32 v13, 16, v50
    v_and_b32 v50, 0xffff0000, v50
    v_fmaak_f32 v30, v13, v118, 0x4b400000
    v_fmaak_f32 v31, v50, v118, 0x4b400000
    v_lshl_add_u64 v[30:31], v[30:31], 0, s[16:17]
    ds_add_rtn_u64 v[30:31], v76, v[30:31] offset:65528
    v_lshlrev_b32 v13, 16, v51
    v_and_b32 v51, 0xffff0000, v51
    v_fmaak_f32 v32, v13, v119, 0x4b400000
    v_fmaak_f32 v33, v51, v119, 0x4b400000
    v_lshl_add_u64 v[32:33], v[32:33], 0, s[16:17]
    ds_add_rtn_u64 v[32:33], v77, v[32:33] offset:65528
    v_lshlrev_b32 v13, 16, v52
    v_and_b32 v52, 0xffff0000, v52
    v_fmaak_f32 v34, v13, v120, 0x4b400000
    v_fmaak_f32 v35, v52, v120, 0x4b400000
    v_lshl_add_u64 v[34:35], v[34:35], 0, s[16:17]
    ds_add_rtn_u64 v[34:35], v78, v[34:35] offset:65528
    v_lshlrev_b32 v13, 16, v53
    v_and_b32 v53, 0xffff0000, v53
    v_fmaak_f32 v36, v13, v121, 0x4b400000
    v_fmaak_f32 v37, v53, v121, 0x4b400000
    v_lshl_add_u64 v[36:37], v[36:37], 0, s[16:17]
    ds_add_rtn_u64 v[36:37], v79, v[36:37] offset:65528
    s_mov_b64 exec, -1
gem_acc_kernel_A_xs3:
    s_sub_i32 s50, s78, 126
    s_min_i32 s50, s50, 63
    s_max_i32 s50, s50, 1
    s_bfm_b64 s[32:33], s50, 0
    s_mov_b64 exec, s[32:33]
    global_load_dwordx4 v[70:73], v18, s[10:11] offset:3024
    global_load_dwordx2 v[74:75], v18, s[10:11] offset:3040
    s_mov_b64 exec, -1
    s_cmp_le_u32 s18, 4
    s_cbranch_scc1 gem_acc_kernel_A_xs4
    s_waitcnt lgkmcnt(4)
    v_or3_b32 v11, v11, v22, v23
    v_or3_b32 v11, v11, v24, v25
    v_or3_b32 v11, v11, v26, v27
    v_or3_b32 v11, v11, v28, v29
    s_mov_b64 exec, s[36:37]
    v_lshlrev_b32 v118, 16, v86
    v_and_b32 v119, 0xffff0000, v86
    v_lshlrev_b32 v120, 16, v87
    v_and_b32 v121, 0xffff0000, v87
    v_mul_f32 v118, v10, v118
    v_mul_f32 v119, v10, v119
    v_mul_f32 v120, v10, v120
    v_mul_f32 v121, v10, v121
    v_lshlrev_b32 v13, 16, v54
    v_and_b32 v54, 0xffff0000, v54
    v_fmaak_f32 v22, v13, v118, 0x4b400000
    v_fmaak_f32 v23, v54, v118, 0x4b400000
    v_lshl_add_u64 v[22:23], v[22:23], 0, s[16:17]
    ds_add_rtn_u64 v[22:23], v82, v[22:23] offset:65528
    v_lshlrev_b32 v13, 16, v55
    v_and_b32 v55, 0xffff0000, v55
    v_fmaak_f32 v24, v13, v119, 0x4b400000
    v_fmaak_f32 v25, v55, v119, 0x4b400000
    v_lshl_add_u64 v[24:25], v[24:25], 0, s[16:17]
    ds_add_rtn_u64 v[24:25], v83, v[24:25] offset:65528
    v_lshlrev_b32 v13, 16, v56
    v_and_b32 v56, 0xffff0000, v56
    v_fmaak_f32 v26, v13, v120, 0x4b400000
    v_fmaak_f32 v27, v56, v120, 0x4b400000
    v_lshl_add_u64 v[26:27], v[26:27], 0, s[16:17]
    ds_add_rtn_u64 v[26:27], v84, v[26:27] offset:65528
    v_lshlrev_b32 v13, 16, v57
    v_and_b32 v57, 0xffff0000, v57
    v_fmaak_f32 v28, v13, v121, 0x4b400000
    v_fmaak_f32 v29, v57, v121, 0x4b400000
    v_lshl_add_u64 v[28:29], v[28:29], 0, s[16:17]
    ds_add_rtn_u64 v[28:29], v85, v[28:29] offset:65528
    s_mov_b64 exec, -1
gem_acc_kernel_A_xs4:
    s_cmp_eq_u32 s19, 0
    s_cbranch_scc1 gem_acc_kernel_A_cont
    s_cmp_eq_u32 s20, 4
    s_cbranch_scc1 gem_acc_kernel_out
gem_acc_kernel_A_cont:
    s_branch gem_acc_kernel_bodyB
gem_acc_kernel_out:
    s_mov_b64 s[20:21], s[86:87]
    s_mov_b64 s[22:23], s[88:89]
    s_mov_b64 s[24:25], s[90:91]
    s_mov_b64 s[28:29], s[92:93]
    s_mov_b64 s[30:31], s[94:95]
    s_mov_b64 s[32:33], s[96:97]
    s_mov_b64 s[34:35], s[98:99]
    v_mbcnt_lo_u32_b32 v0, -1, 0
    v_mbcnt_hi_u32_b32 v0, -1, v0
    s_lshl_b32 s48, s9, 6
    v_add_u32 v0, s48, v0
    s_waitcnt vmcnt(0)
    s_lshl_b32 s48, s6, 1
    s_add_u32 s48, s48, s8
    s_mul_i32 s50, s7, 10000
    s_mul_i32 s51, s48, 1250
    s_add_u32 s50, s50, s51
    v_lshlrev_b32 v1, 1, v0
    v_add_u32 v1, s50, v1
    v_lshlrev_b32 v2, 3, v1
    v_lshlrev_b32 v3, 1, v1
    v_lshlrev_b32 v4, 2, v1
    s_mov_b32 s51, 625
    v_cmp_gt_u32 s[64:65], s51, v0
    s_mov_b64 s[18:19], s[30:31]
    s_mov_b64 s[16:17], s[34:35]
    s_mov_b64 exec, s[64:65]
    s_cbranch_execz gem_acc_kernel_nomd
    global_load_dwordx4 v[40:43], v2, s[20:21]
    global_load_dword v5, v3, s[22:23]
gem_acc_kernel_nomd:
    s_mov_b64 exec, -1
    s_load_dwordx4 s[20:23], s[24:25], 0
    s_load_dwordx16 s[68:83], s[28:29], 0
    s_load_dwordx16 s[36:51], s[18:19], 0
    s_load_dwordx8 s[24:31], s[32:33], 0
    s_waitcnt lgkmcnt(0)
    v_or3_b32 v11, v11, v22, v23
    v_or3_b32 v11, v11, v24, v25
    v_or3_b32 v11, v11, v26, v27
    v_or3_b32 v11, v11, v28, v29
    v_or3_b32 v11, v11, v30, v31
    v_or3_b32 v11, v11, v32, v33
    v_or3_b32 v11, v11, v34, v35
    v_or3_b32 v11, v11, v36, v37
    s_barrier
    v_mov_b32 v74, 0
    v_mov_b32 v75, 0
    v_mov_b32 v76, 0
    v_mov_b32 v77, 0
    v_mov_b32 v78, 0
    v_mov_b32 v79, 0
    v_mov_b32 v80, 0
    v_mov_b32 v81, 0
    v_lshlrev_b32 v13, 5, v0
    v_add_u32 v13, 65536, v13
    v_add_u32 v15, 65536, v13
    v_cmp_gt_u32 vcc, 452, v0
    s_and_saveexec_b64 s[66:67], vcc
    ds_read_b128 v[74:77], v15
    ds_read_b128 v[78:81], v15 offset:16
    s_mov_b64 exec, s[66:67]
    ds_read_b128 v[58:61], v13 offset:0
    ds_read_b128 v[62:65], v13 offset:16
    ds_read_b128 v[66:69], v13 offset:32768
    ds_read_b128 v[70:73], v13 offset:32784
    s_waitcnt lgkmcnt(0)
    v_or3_b32 v11, v11, v58, v59
    v_or3_b32 v11, v11, v60, v61
    v_or3_b32 v11, v11, v62, v63
    v_or3_b32 v11, v11, v64, v65
    v_or3_b32 v11, v11, v66, v67
    v_or3_b32 v11, v11, v68, v69
    v_or3_b32 v11, v11, v70, v71
    v_or3_b32 v11, v11, v72, v73
    v_or3_b32 v11, v11, v74, v75
    v_or3_b32 v11, v11, v76, v77
    v_or3_b32 v11, v11, v78, v79
    v_or3_b32 v11, v11, v80, v81
    v_cmp_gt_i32 vcc, 0, v11
    v_mov_b32 v13, 145600
    v_mov_b32 v15, 1
    s_cmp_eq_u64 vcc, 0
    s_cbranch_scc1 gem_acc_kernel_noflag
    ds_write_b32 v13, v15
gem_acc_kernel_noflag:
    v_add_u32 v58, 0xc0000000, v58
    v_add_u32 v59, 0xc0000000, v59
    v_add_u32 v60, 0xc0000000, v60
    v_add_u32 v61, 0xc0000000, v61
    v_add_u32 v62, 0xc0000000, v62
    v_add_u32 v63, 0xc0000000, v63
    v_add_u32 v64, 0xc0000000, v64
    v_add_u32 v65, 0xc0000000, v65
    v_add_u32 v66, 0xc0000000, v66
    v_add_u32 v67, 0xc0000000, v67
    v_add_u32 v68, 0xc0000000, v68
    v_add_u32 v69, 0xc0000000, v69
    v_add_u32 v70, 0xc0000000, v70
    v_add_u32 v71, 0xc0000000, v71
    v_add_u32 v72, 0xc0000000, v72
    v_add_u32 v73, 0xc0000000, v73
    v_add_u32 v74, 0xc0000000, v74
    v_add_u32 v75, 0xc0000000, v75
    v_add_u32 v76, 0xc0000000, v76
    v_add_u32 v77, 0xc0000000, v77
    v_add_u32 v78, 0xc0000000, v78
    v_add_u32 v79, 0xc0000000, v79
    v_add_u32 v80, 0xc0000000, v80
    v_add_u32 v81, 0xc0000000, v81
    v_cvt_f32_i32 v58, v58
    v_cvt_f32_i32 v59, v59
    v_cvt_f32_i32 v60, v60
    v_cvt_f32_i32 v61, v61
    v_cvt_f32_i32 v62, v62
    v_cvt_f32_i32 v63, v63
    v_cvt_f32_i32 v64, v64
    v_cvt_f32_i32 v65, v65
    v_cvt_f32_i32 v66, v66
    v_cvt_f32_i32 v67, v67
    v_cvt_f32_i32 v68, v68
    v_cvt_f32_i32 v69, v69
    v_cvt_f32_i32 v70, v70
    v_cvt_f32_i32 v71, v71
    v_cvt_f32_i32 v72, v72
    v_cvt_f32_i32 v73, v73
    v_cvt_f32_i32 v74, v74
    v_cvt_f32_i32 v75, v75
    v_cvt_f32_i32 v76, v76
    v_cvt_f32_i32 v77, v77
    v_cvt_f32_i32 v78, v78
    v_cvt_f32_i32 v79, v79
    v_cvt_f32_i32 v80, v80
    v_cvt_f32_i32 v81, v81
    v_mul_f32 v58, 0x38000000, v58
    v_mul_f32 v59, 0x38000000, v59
    v_mul_f32 v60, 0x38000000, v60
    v_mul_f32 v61, 0x38000000, v61
    v_mul_f32 v62, 0x38000000, v62
    v_mul_f32 v63, 0x38000000, v63
    v_mul_f32 v64, 0x38000000, v64
    v_mul_f32 v65, 0x38000000, v65
    v_mul_f32 v66, 0x38000000, v66
    v_mul_f32 v67, 0x38000000, v67
    v_mul_f32 v68, 0x38000000, v68
    v_mul_f32 v69, 0x38000000, v69
    v_mul_f32 v70, 0x38000000, v70
    v_mul_f32 v71, 0x38000000, v71
    v_mul_f32 v72, 0x38000000, v72
    v_mul_f32 v73, 0x38000000, v73
    v_mul_f32 v74, 0x38000000, v74
    v_mul_f32 v75, 0x38000000, v75
    v_mul_f32 v76, 0x38000000, v76
    v_mul_f32 v77, 0x38000000, v77
    v_mul_f32 v78, 0x38000000, v78
    v_mul_f32 v79, 0x38000000, v79
    v_mul_f32 v80, 0x38000000, v80
    v_mul_f32 v81, 0x38000000, v81
    v_cvt_pk_f16_f32 v82, v58, v59
    v_cvt_pk_f16_f32 v83, v60, v61
    v_cvt_pk_f16_f32 v84, v62, v63
    v_cvt_pk_f16_f32 v85, v64, v65
    v_cvt_pk_f16_f32 v86, v66, v67
    v_cvt_pk_f16_f32 v87, v68, v69
    v_cvt_pk_f16_f32 v88, v70, v71
    v_cvt_pk_f16_f32 v89, v72, v73
    v_cvt_pk_f16_f32 v90, v74, v75
    v_cvt_pk_f16_f32 v91, v76, v77
    v_cvt_pk_f16_f32 v92, v78, v79
    v_cvt_pk_f16_f32 v93, v80, v81
    s_lshl_b32 s10, s6, 1
    s_add_u32 s10, s10, s8
    s_mul_i32 s11, s10, 1280000
    s_mul_i32 s12, s7, 40000
    s_add_u32 s11, s11, s12
    s_add_u32 s11, s11, 71110656
    s_add_u32 s54, s4, s11
    s_addc_u32 s55, s5, 0
    v_lshlrev_b32 v13, 4, v0
    s_waitcnt vmcnt(0)
    global_store_dwordx4 v13, v[82:85], s[54:55] sc1
    v_add_u32 v15, 16384, v13
    global_store_dwordx4 v15, v[86:89], s[54:55] sc1
    v_add_u32 v15, 32768, v13
    v_cmp_gt_u32 vcc, 452, v0
    s_and_saveexec_b64 s[66:67], vcc
    s_cbranch_execz gem_acc_kernel_nost3
    global_store_dwordx4 v15, v[90:93], s[54:55] sc1
gem_acc_kernel_nost3:
    s_mov_b64 exec, s[66:67]
    s_cmp_eq_u32 s9, 0
    s_cbranch_scc0 gem_acc_kernel_nosc
    s_lshl_b32 s11, s10, 5
    s_add_u32 s11, s11, s7
    s_lshl_b32 s11, s11, 2
    s_add_u32 s11, s11, 81350656
    s_add_u32 s56, s4, s11
    s_addc_u32 s57, s5, 0
    v_mov_b32 v15, s15
    v_mul_f32 v15, 0x47000000, v15
    v_mov_b32 v16, 0
    s_mov_b64 exec, 1
    global_store_dword v16, v15, s[56:57] sc1
    s_mov_b64 exec, -1
gem_acc_kernel_nosc:
    s_waitcnt lgkmcnt(0)
    s_lshl_b32 s84, s20, 16
    s_and_b32 s85, s20, 0xffff0000
    s_lshl_b32 s86, s21, 16
    s_and_b32 s87, s21, 0xffff0000
    s_lshl_b32 s88, s22, 16
    s_and_b32 s89, s22, 0xffff0000
    s_lshl_b32 s90, s23, 16
    s_and_b32 s91, s23, 0xffff0000
    s_pack_ll_b32_b16 s52, s68, s70
    s_pack_hh_b32_b16 s53, s68, s70
    s_pack_ll_b32_b16 s54, s69, s71
    s_pack_hh_b32_b16 s55, s69, s71
    s_pack_ll_b32_b16 s56, s72, s74
    s_pack_hh_b32_b16 s57, s72, s74
    s_pack_ll_b32_b16 s58, s73, s75
    s_pack_hh_b32_b16 s59, s73, s75
    s_pack_ll_b32_b16 s60, s76, s78
    s_pack_hh_b32_b16 s61, s76, s78
    s_pack_ll_b32_b16 s62, s77, s79
    s_pack_hh_b32_b16 s63, s77, s79
    s_pack_ll_b32_b16 s92, s80, s82
    s_pack_hh_b32_b16 s93, s80, s82
    s_pack_ll_b32_b16 s94, s81, s83
    s_pack_hh_b32_b16 s95, s81, s83
    s_pack_ll_b32_b16 s68, s36, s38
    s_pack_hh_b32_b16 s69, s36, s38
    s_pack_ll_b32_b16 s70, s37, s39
    s_pack_hh_b32_b16 s71, s37, s39
    s_pack_ll_b32_b16 s72, s40, s42
    s_pack_hh_b32_b16 s73, s40, s42
    s_pack_ll_b32_b16 s74, s41, s43
    s_pack_hh_b32_b16 s75, s41, s43
    s_pack_ll_b32_b16 s76, s44, s46
    s_pack_hh_b32_b16 s77, s44, s46
    s_pack_ll_b32_b16 s78, s45, s47
    s_pack_hh_b32_b16 s79, s45, s47
    s_pack_ll_b32_b16 s80, s48, s50
    s_pack_hh_b32_b16 s81, s48, s50
    s_pack_ll_b32_b16 s82, s49, s51
    s_pack_hh_b32_b16 s83, s49, s51
    s_lshl_b32 s36, s24, 16
    s_and_b32 s37, s24, 0xffff0000
    s_lshl_b32 s38, s25, 16
    s_and_b32 s39, s25, 0xffff0000
    s_lshl_b32 s40, s26, 16
    s_and_b32 s41, s26, 0xffff0000
    s_lshl_b32 s42, s27, 16
    s_and_b32 s43, s27, 0xffff0000
    s_lshl_b32 s44, s28, 16
    s_and_b32 s45, s28, 0xffff0000
    s_lshl_b32 s46, s29, 16
    s_and_b32 s47, s29, 0xffff0000
    s_lshl_b32 s48, s30, 16
    s_and_b32 s49, s30, 0xffff0000
    s_lshl_b32 s50, s31, 16
    s_and_b32 s51, s31, 0xffff0000
    s_mov_b32 s20, 0xc1200000
    s_mov_b32 s21, 0x3fb8aa3b
    s_cmp_eq_u64 s[64:65], 0
    s_cbranch_scc1 gem_acc_kernel_nopre
    v_lshlrev_b32 v48, 16, v5
    v_subrev_f32 v49, s84, v48
    v_subrev_f32 v50, s85, v48
    v_subrev_f32 v51, s86, v48
    v_subrev_f32 v52, s87, v48
    v_subrev_f32 v53, s88, v48
    v_subrev_f32 v54, s89, v48
    v_subrev_f32 v55, s90, v48
    v_subrev_f32 v56, s91, v48
    v_cvt_pk_bf16_f32 v57, v49, v50
    v_lshlrev_b32 v49, 16, v57
    v_and_b32 v50, 0xffff0000, v57
    v_cvt_pk_bf16_f32 v57, v51, v52
    v_lshlrev_b32 v51, 16, v57
    v_and_b32 v52, 0xffff0000, v57
    v_cvt_pk_bf16_f32 v57, v53, v54
    v_lshlrev_b32 v53, 16, v57
    v_and_b32 v54, 0xffff0000, v57
    v_cvt_pk_bf16_f32 v57, v55, v56
    v_lshlrev_b32 v55, 16, v57
    v_and_b32 v56, 0xffff0000, v57
    v_mul_f32 v49, v49, v49
    v_mul_f32 v50, v50, v50
    v_mul_f32 v51, v51, v51
    v_mul_f32 v52, v52, v52
    v_mul_f32 v53, v53, v53
    v_mul_f32 v54, v54, v54
    v_mul_f32 v55, v55, v55
    v_mul_f32 v56, v56, v56
    v_cvt_pk_bf16_f32 v57, v49, v50
    v_lshlrev_b32 v49, 16, v57
    v_and_b32 v50, 0xffff0000, v57
    v_cvt_pk_bf16_f32 v57, v51, v52
    v_lshlrev_b32 v51, 16, v57
    v_and_b32 v52, 0xffff0000, v57
    v_cvt_pk_bf16_f32 v57, v53, v54
    v_lshlrev_b32 v53, 16, v57
    v_and_b32 v54, 0xffff0000, v57
    v_cvt_pk_bf16_f32 v57, v55, v56
    v_lshlrev_b32 v55, 16, v57
    v_and_b32 v56, 0xffff0000, v57
    v_mul_f32 v49, s20, v49
    v_mul_f32 v50, s20, v50
    v_mul_f32 v51, s20, v51
    v_mul_f32 v52, s20, v52
    v_mul_f32 v53, s20, v53
    v_mul_f32 v54, s20, v54
    v_mul_f32 v55, s20, v55
    v_mul_f32 v56, s20, v56
    v_cvt_pk_bf16_f32 v57, v49, v50
    v_lshlrev_b32 v49, 16, v57
    v_and_b32 v50, 0xffff0000, v57
    v_cvt_pk_bf16_f32 v57, v51, v52
    v_lshlrev_b32 v51, 16, v57
    v_and_b32 v52, 0xffff0000, v57
    v_cvt_pk_bf16_f32 v57, v53, v54
    v_lshlrev_b32 v53, 16, v57
    v_and_b32 v54, 0xffff0000, v57
    v_cvt_pk_bf16_f32 v57, v55, v56
    v_lshlrev_b32 v55, 16, v57
    v_and_b32 v56, 0xffff0000, v57
    v_mul_f32 v49, s21, v49
    v_mul_f32 v50, s21, v50
    v_mul_f32 v51, s21, v51
    v_mul_f32 v52, s21, v52
    v_mul_f32 v53, s21, v53
    v_mul_f32 v54, s21, v54
    v_mul_f32 v55, s21, v55
    v_mul_f32 v56, s21, v56
    v_exp_f32 v49, v49
    v_exp_f32 v50, v50
    v_exp_f32 v51, v51
    v_exp_f32 v52, v52
    v_exp_f32 v53, v53
    v_exp_f32 v54, v54
    v_exp_f32 v55, v55
    v_exp_f32 v56, v56
    s_nop 0
    v_cvt_pk_bf16_f32 v94, v49, v50
    v_cvt_pk_bf16_f32 v95, v51, v52
    v_cvt_pk_bf16_f32 v96, v53, v54
    v_cvt_pk_bf16_f32 v97, v55, v56
    v_mov_b32 v24, 0
    v_mov_b32 v32, 0
    v_mov_b32 v25, 0
    v_mov_b32 v33, 0
    v_mov_b32 v26, 0
    v_mov_b32 v34, 0
    v_mov_b32 v27, 0
    v_mov_b32 v35, 0
    v_dot2_f32_bf16 v24, v94, s68, v24
    v_dot2_f32_bf16 v32, v94, s52, v32
    v_dot2_f32_bf16 v25, v94, s69, v25
    v_dot2_f32_bf16 v33, v94, s53, v33
    v_dot2_f32_bf16 v26, v94, s70, v26
    v_dot2_f32_bf16 v34, v94, s54, v34
    v_dot2_f32_bf16 v27, v94, s71, v27
    v_dot2_f32_bf16 v35, v94, s55, v35
    v_dot2_f32_bf16 v24, v95, s72, v24
    v_dot2_f32_bf16 v32, v95, s56, v32
    v_dot2_f32_bf16 v25, v95, s73, v25
    v_dot2_f32_bf16 v33, v95, s57, v33
    v_dot2_f32_bf16 v26, v95, s74, v26
    v_dot2_f32_bf16 v34, v95, s58, v34
    v_dot2_f32_bf16 v27, v95, s75, v27
    v_dot2_f32_bf16 v35, v95, s59, v35
    v_dot2_f32_bf16 v24, v96, s76, v24
    v_dot2_f32_bf16 v32, v96, s60, v32
    v_dot2_f32_bf16 v25, v96, s77, v25
    v_dot2_f32_bf16 v33, v96, s61, v33
    v_dot2_f32_bf16 v26, v96, s78, v26
    v_dot2_f32_bf16 v34, v96, s62, v34
    v_dot2_f32_bf16 v27, v96, s79, v27
    v_dot2_f32_bf16 v35, v96, s63, v35
    v_dot2_f32_bf16 v24, v97, s80, v24
    v_dot2_f32_bf16 v32, v97, s92, v32
    v_dot2_f32_bf16 v25, v97, s81, v25
    v_dot2_f32_bf16 v33, v97, s93, v33
    v_dot2_f32_bf16 v26, v97, s82, v26
    v_dot2_f32_bf16 v34, v97, s94, v34
    v_dot2_f32_bf16 v27, v97, s83, v27
    v_dot2_f32_bf16 v35, v97, s95, v35
    s_nop 2
    v_cvt_pk_bf16_f32 v57, v32, v33
    v_lshlrev_b32 v32, 16, v57
    v_and_b32 v33, 0xffff0000, v57
    v_cvt_pk_bf16_f32 v57, v34, v35
    v_lshlrev_b32 v34, 16, v57
    v_and_b32 v35, 0xffff0000, v57
    v_and_b32 v48, 0xffff0000, v5
    v_subrev_f32 v49, s84, v48
    v_subrev_f32 v50, s85, v48
    v_subrev_f32 v51, s86, v48
    v_subrev_f32 v52, s87, v48
    v_subrev_f32 v53, s88, v48
    v_subrev_f32 v54, s89, v48
    v_subrev_f32 v55, s90, v48
    v_subrev_f32 v56, s91, v48
    v_cvt_pk_bf16_f32 v57, v49, v50
    v_lshlrev_b32 v49, 16, v57
    v_and_b32 v50, 0xffff0000, v57
    v_cvt_pk_bf16_f32 v57, v51, v52
    v_lshlrev_b32 v51, 16, v57
    v_and_b32 v52, 0xffff0000, v57
    v_cvt_pk_bf16_f32 v57, v53, v54
    v_lshlrev_b32 v53, 16, v57
    v_and_b32 v54, 0xffff0000, v57
    v_cvt_pk_bf16_f32 v57, v55, v56
    v_lshlrev_b32 v55, 16, v57
    v_and_b32 v56, 0xffff0000, v57
    v_mul_f32 v49, v49, v49
    v_mul_f32 v50, v50, v50
    v_mul_f32 v51, v51, v51
    v_mul_f32 v52, v52, v52
    v_mul_f32 v53, v53, v53
    v_mul_f32 v54, v54, v54
    v_mul_f32 v55, v55, v55
    v_mul_f32 v56, v56, v56
    v_cvt_pk_bf16_f32 v57, v49, v50
    v_lshlrev_b32 v49, 16, v57
    v_and_b32 v50, 0xffff0000, v57
    v_cvt_pk_bf16_f32 v57, v51, v52
    v_lshlrev_b32 v51, 16, v57
    v_and_b32 v52, 0xffff0000, v57
    v_cvt_pk_bf16_f32 v57, v53, v54
    v_lshlrev_b32 v53, 16, v57
    v_and_b32 v54, 0xffff0000, v57
    v_cvt_pk_bf16_f32 v57, v55, v56
    v_lshlrev_b32 v55, 16, v57
    v_and_b32 v56, 0xffff0000, v57
    v_mul_f32 v49, s20, v49
    v_mul_f32 v50, s20, v50
    v_mul_f32 v51, s20, v51
    v_mul_f32 v52, s20, v52
    v_mul_f32 v53, s20, v53
    v_mul_f32 v54, s20, v54
    v_mul_f32 v55, s20, v55
    v_mul_f32 v56, s20, v56
    v_cvt_pk_bf16_f32 v57, v49, v50
    v_lshlrev_b32 v49, 16, v57
    v_and_b32 v50, 0xffff0000, v57
    v_cvt_pk_bf16_f32 v57, v51, v52
    v_lshlrev_b32 v51, 16, v57
    v_and_b32 v52, 0xffff0000, v57
    v_cvt_pk_bf16_f32 v57, v53, v54
    v_lshlrev_b32 v53, 16, v57
    v_and_b32 v54, 0xffff0000, v57
    v_cvt_pk_bf16_f32 v57, v55, v56
    v_lshlrev_b32 v55, 16, v57
    v_and_b32 v56, 0xffff0000, v57
    v_mul_f32 v49, s21, v49
    v_mul_f32 v50, s21, v50
    v_mul_f32 v51, s21, v51
    v_mul_f32 v52, s21, v52
    v_mul_f32 v53, s21, v53
    v_mul_f32 v54, s21, v54
    v_mul_f32 v55, s21, v55
    v_mul_f32 v56, s21, v56
    v_exp_f32 v49, v49
    v_exp_f32 v50, v50
    v_exp_f32 v51, v51
    v_exp_f32 v52, v52
    v_exp_f32 v53, v53
    v_exp_f32 v54, v54
    v_exp_f32 v55, v55
    v_exp_f32 v56, v56
    s_nop 0
    v_cvt_pk_bf16_f32 v94, v49, v50
    v_cvt_pk_bf16_f32 v95, v51, v52
    v_cvt_pk_bf16_f32 v96, v53, v54
    v_cvt_pk_bf16_f32 v97, v55, v56
    v_mov_b32 v28, 0
    v_mov_b32 v36, 0
    v_mov_b32 v29, 0
    v_mov_b32 v37, 0
    v_mov_b32 v30, 0
    v_mov_b32 v38, 0
    v_mov_b32 v31, 0
    v_mov_b32 v39, 0
    v_dot2_f32_bf16 v28, v94, s68, v28
    v_dot2_f32_bf16 v36, v94, s52, v36
    v_dot2_f32_bf16 v29, v94, s69, v29
    v_dot2_f32_bf16 v37, v94, s53, v37
    v_dot2_f32_bf16 v30, v94, s70, v30
    v_dot2_f32_bf16 v38, v94, s54, v38
    v_dot2_f32_bf16 v31, v94, s71, v31
    v_dot2_f32_bf16 v39, v94, s55, v39
    v_dot2_f32_bf16 v28, v95, s72, v28
    v_dot2_f32_bf16 v36, v95, s56, v36
    v_dot2_f32_bf16 v29, v95, s73, v29
    v_dot2_f32_bf16 v37, v95, s57, v37
    v_dot2_f32_bf16 v30, v95, s74, v30
    v_dot2_f32_bf16 v38, v95, s58, v38
    v_dot2_f32_bf16 v31, v95, s75, v31
    v_dot2_f32_bf16 v39, v95, s59, v39
    v_dot2_f32_bf16 v28, v96, s76, v28
    v_dot2_f32_bf16 v36, v96, s60, v36
    v_dot2_f32_bf16 v29, v96, s77, v29
    v_dot2_f32_bf16 v37, v96, s61, v37
    v_dot2_f32_bf16 v30, v96, s78, v30
    v_dot2_f32_bf16 v38, v96, s62, v38
    v_dot2_f32_bf16 v31, v96, s79, v31
    v_dot2_f32_bf16 v39, v96, s63, v39
    v_dot2_f32_bf16 v28, v97, s80, v28
    v_dot2_f32_bf16 v36, v97, s92, v36
    v_dot2_f32_bf16 v29, v97, s81, v29
    v_dot2_f32_bf16 v37, v97, s93, v37
    v_dot2_f32_bf16 v30, v97, s82, v30
    v_dot2_f32_bf16 v38, v97, s94, v38
    v_dot2_f32_bf16 v31, v97, s83, v31
    v_dot2_f32_bf16 v39, v97, s95, v39
    s_nop 2
    v_cvt_pk_bf16_f32 v57, v36, v37
    v_lshlrev_b32 v36, 16, v57
    v_and_b32 v37, 0xffff0000, v57
    v_cvt_pk_bf16_f32 v57, v38, v39
    v_lshlrev_b32 v38, 16, v57
    v_and_b32 v39, 0xffff0000, v57
gem_acc_kernel_nopre:
    s_waitcnt vmcnt(0) lgkmcnt(0)
    s_barrier
    v_mov_b32 v13, 145600
    ds_read_b32 v15, v13
    s_waitcnt lgkmcnt(0)
    v_readfirstlane_b32 s98, v15
    s_nop 3
    s_cmp_eq_u32 s98, 0
    s_cbranch_scc1 gem_acc_kernel_good
    s_add_u32 s14, s14, 1
    s_cmp_ge_u32 s14, 12
    s_cbranch_scc1 gem_acc_kernel_good
    s_barrier
    s_branch gem_acc_kernel_redo
gem_acc_kernel_good:
    s_lshl_b32 s52, s7, 7
    s_add_u32 s52, s52, 81354752
    s_add_u32 s54, s4, s52
    s_addc_u32 s55, s5, 0
    s_cmp_eq_u32 s9, 0
    s_cbranch_scc0 gem_acc_kernel_nopoll
    v_mov_b32 v6, 0
    v_mov_b32 v7, 1
    s_mov_b64 exec, 1
    global_atomic_add v6, v7, s[54:55]
    s_mov_b32 s53, 0
gem_acc_kernel_poll:
    global_load_dword v7, v6, s[54:55] sc1
    s_waitcnt vmcnt(0)
    v_readfirstlane_b32 s52, v7
    s_add_u32 s53, s53, 1
    s_cmp_ge_u32 s52, 8
    s_cbranch_scc1 gem_acc_kernel_polled
    s_cmp_ge_u32 s53, 0x100000
    s_cbranch_scc1 gem_acc_kernel_polled
    s_sleep 1
    s_branch gem_acc_kernel_poll
gem_acc_kernel_polled:
    s_mov_b64 exec, -1
gem_acc_kernel_nopoll:
    s_barrier
    s_cmp_eq_u64 s[64:65], 0
    s_cbranch_scc1 gem_acc_kernel_fin
    s_add_u32 s54, s4, 71110656
    s_addc_u32 s55, s5, 0
    s_mov_b64 exec, s[64:65]
    global_load_dwordx2 v[70:71], v4, s[54:55] sc1
    s_add_u32 s54, s54, 1280000
    s_addc_u32 s55, s55, 0
    global_load_dwordx2 v[72:73], v4, s[54:55] sc1
    s_add_u32 s54, s54, 1280000
    s_addc_u32 s55, s55, 0
    global_load_dwordx2 v[74:75], v4, s[54:55] sc1
    s_add_u32 s54, s54, 1280000
    s_addc_u32 s55, s55, 0
    global_load_dwordx2 v[76:77], v4, s[54:55] sc1
    s_add_u32 s54, s54, 1280000
    s_addc_u32 s55, s55, 0
    global_load_dwordx2 v[78:79], v4, s[54:55] sc1
    s_add_u32 s54, s54, 1280000
    s_addc_u32 s55, s55, 0
    global_load_dwordx2 v[80:81], v4, s[54:55] sc1
    s_add_u32 s54, s54, 1280000
    s_addc_u32 s55, s55, 0
    global_load_dwordx2 v[82:83], v4, s[54:55] sc1
    s_add_u32 s54, s54, 1280000
    s_addc_u32 s55, s55, 0
    global_load_dwordx2 v[84:85], v4, s[54:55] sc1
    s_mov_b64 exec, -1
    v_mbcnt_lo_u32_b32 v6, -1, 0
    v_mbcnt_hi_u32_b32 v6, -1, v6
    v_and_b32 v6, 7, v6
    v_lshlrev_b32 v6, 7, v6
    s_lshl_b32 s22, s7, 2
    s_add_u32 s22, s22, 81350656
    s_add_u32 s22, s4, s22
    s_addc_u32 s23, s5, 0
    global_load_dword v7, v6, s[22:23] sc1
    s_waitcnt vmcnt(0)
    v_readlane_b32 s24, v7, 0
    v_readlane_b32 s25, v7, 1
    v_readlane_b32 s26, v7, 2
    v_readlane_b32 s27, v7, 3
    v_readlane_b32 s28, v7, 4
    v_readlane_b32 s29, v7, 5
    v_readlane_b32 s30, v7, 6
    v_readlane_b32 s31, v7, 7
    s_nop 1
    v_fma_mix_f32 v58, v70, s24, 0 op_sel:[0,0,0] op_sel_hi:[1,0,0]
    v_fma_mix_f32 v58, v74, s26, v58 op_sel:[0,0,0] op_sel_hi:[1,0,0]
    v_fma_mix_f32 v58, v78, s28, v58 op_sel:[0,0,0] op_sel_hi:[1,0,0]
    v_fma_mix_f32 v58, v82, s30, v58 op_sel:[0,0,0] op_sel_hi:[1,0,0]
    v_fma_mix_f32 v59, v70, s24, 0 op_sel:[1,0,0] op_sel_hi:[1,0,0]
    v_fma_mix_f32 v59, v74, s26, v59 op_sel:[1,0,0] op_sel_hi:[1,0,0]
    v_fma_mix_f32 v59, v78, s28, v59 op_sel:[1,0,0] op_sel_hi:[1,0,0]
    v_fma_mix_f32 v59, v82, s30, v59 op_sel:[1,0,0] op_sel_hi:[1,0,0]
    v_fma_mix_f32 v60, v72, s25, 0 op_sel:[0,0,0] op_sel_hi:[1,0,0]
    v_fma_mix_f32 v60, v76, s27, v60 op_sel:[0,0,0] op_sel_hi:[1,0,0]
    v_fma_mix_f32 v60, v80, s29, v60 op_sel:[0,0,0] op_sel_hi:[1,0,0]
    v_fma_mix_f32 v60, v84, s31, v60 op_sel:[0,0,0] op_sel_hi:[1,0,0]
    v_fma_mix_f32 v61, v72, s25, 0 op_sel:[1,0,0] op_sel_hi:[1,0,0]
    v_fma_mix_f32 v61, v76, s27, v61 op_sel:[1,0,0] op_sel_hi:[1,0,0]
    v_fma_mix_f32 v61, v80, s29, v61 op_sel:[1,0,0] op_sel_hi:[1,0,0]
    v_fma_mix_f32 v61, v84, s31, v61 op_sel:[1,0,0] op_sel_hi:[1,0,0]
    v_fma_mix_f32 v62, v71, s24, 0 op_sel:[0,0,0] op_sel_hi:[1,0,0]
    v_fma_mix_f32 v62, v75, s26, v62 op_sel:[0,0,0] op_sel_hi:[1,0,0]
    v_fma_mix_f32 v62, v79, s28, v62 op_sel:[0,0,0] op_sel_hi:[1,0,0]
    v_fma_mix_f32 v62, v83, s30, v62 op_sel:[0,0,0] op_sel_hi:[1,0,0]
    v_fma_mix_f32 v63, v71, s24, 0 op_sel:[1,0,0] op_sel_hi:[1,0,0]
    v_fma_mix_f32 v63, v75, s26, v63 op_sel:[1,0,0] op_sel_hi:[1,0,0]
    v_fma_mix_f32 v63, v79, s28, v63 op_sel:[1,0,0] op_sel_hi:[1,0,0]
    v_fma_mix_f32 v63, v83, s30, v63 op_sel:[1,0,0] op_sel_hi:[1,0,0]
    v_fma_mix_f32 v64, v73, s25, 0 op_sel:[0,0,0] op_sel_hi:[1,0,0]
    v_fma_mix_f32 v64, v77, s27, v64 op_sel:[0,0,0] op_sel_hi:[1,0,0]
    v_fma_mix_f32 v64, v81, s29, v64 op_sel:[0,0,0] op_sel_hi:[1,0,0]
    v_fma_mix_f32 v64, v85, s31, v64 op_sel:[0,0,0] op_sel_hi:[1,0,0]
    v_fma_mix_f32 v65, v73, s25, 0 op_sel:[1,0,0] op_sel_hi:[1,0,0]
    v_fma_mix_f32 v65, v77, s27, v65 op_sel:[1,0,0] op_sel_hi:[1,0,0]
    v_fma_mix_f32 v65, v81, s29, v65 op_sel:[1,0,0] op_sel_hi:[1,0,0]
    v_fma_mix_f32 v65, v85, s31, v65 op_sel:[1,0,0] op_sel_hi:[1,0,0]
    v_mul_f32 v24, v24, v58
    v_mul_f32 v25, v25, v59
    v_mul_f32 v26, v26, v60
    v_mul_f32 v27, v27, v61
    v_cvt_pk_bf16_f32 v57, v24, v25
    v_lshlrev_b32 v24, 16, v57
    v_and_b32 v25, 0xffff0000, v57
    v_cvt_pk_bf16_f32 v57, v26, v27
    v_lshlrev_b32 v26, 16, v57
    v_and_b32 v27, 0xffff0000, v57
    v_mul_f32 v49, s36, v24
    v_fma_f32 v49, v25, s40, v49
    v_fma_f32 v49, v26, s44, v49
    v_fma_f32 v49, v27, s48, v49
    v_mul_f32 v50, s37, v24
    v_fma_f32 v50, v25, s41, v50
    v_fma_f32 v50, v26, s45, v50
    v_fma_f32 v50, v27, s49, v50
    v_mul_f32 v51, s38, v24
    v_fma_f32 v51, v25, s42, v51
    v_fma_f32 v51, v26, s46, v51
    v_fma_f32 v51, v27, s50, v51
    v_mul_f32 v52, s39, v24
    v_fma_f32 v52, v25, s43, v52
    v_fma_f32 v52, v26, s47, v52
    v_fma_f32 v52, v27, s51, v52
    v_cvt_pk_bf16_f32 v57, v49, v50
    v_lshlrev_b32 v49, 16, v57
    v_and_b32 v50, 0xffff0000, v57
    v_cvt_pk_bf16_f32 v57, v51, v52
    v_lshlrev_b32 v51, 16, v57
    v_and_b32 v52, 0xffff0000, v57
    v_mul_f32 v49, v49, v32
    v_mul_f32 v50, v50, v33
    v_mul_f32 v51, v51, v34
    v_mul_f32 v52, v52, v35
    v_cvt_pk_bf16_f32 v57, v49, v50
    v_lshlrev_b32 v49, 16, v57
    v_and_b32 v50, 0xffff0000, v57
    v_cvt_pk_bf16_f32 v57, v51, v52
    v_lshlrev_b32 v51, 16, v57
    v_and_b32 v52, 0xffff0000, v57
    v_lshlrev_b32 v53, 16, v40
    v_and_b32 v54, 0xffff0000, v40
    v_lshlrev_b32 v55, 16, v41
    v_and_b32 v56, 0xffff0000, v41
    v_add_f32 v49, v49, v53
    v_add_f32 v50, v50, v54
    v_add_f32 v51, v51, v55
    v_add_f32 v52, v52, v56
    v_cvt_pk_bf16_f32 v44, v49, v50
    v_cvt_pk_bf16_f32 v45, v51, v52
    v_mul_f32 v28, v28, v62
    v_mul_f32 v29, v29, v63
    v_mul_f32 v30, v30, v64
    v_mul_f32 v31, v31, v65
    v_cvt_pk_bf16_f32 v57, v28, v29
    v_lshlrev_b32 v28, 16, v57
    v_and_b32 v29, 0xffff0000, v57
    v_cvt_pk_bf16_f32 v57, v30, v31
    v_lshlrev_b32 v30, 16, v57
    v_and_b32 v31, 0xffff0000, v57
    v_mul_f32 v49, s36, v28
    v_fma_f32 v49, v29, s40, v49
    v_fma_f32 v49, v30, s44, v49
    v_fma_f32 v49, v31, s48, v49
    v_mul_f32 v50, s37, v28
    v_fma_f32 v50, v29, s41, v50
    v_fma_f32 v50, v30, s45, v50
    v_fma_f32 v50, v31, s49, v50
    v_mul_f32 v51, s38, v28
    v_fma_f32 v51, v29, s42, v51
    v_fma_f32 v51, v30, s46, v51
    v_fma_f32 v51, v31, s50, v51
    v_mul_f32 v52, s39, v28
    v_fma_f32 v52, v29, s43, v52
    v_fma_f32 v52, v30, s47, v52
    v_fma_f32 v52, v31, s51, v52
    v_cvt_pk_bf16_f32 v57, v49, v50
    v_lshlrev_b32 v49, 16, v57
    v_and_b32 v50, 0xffff0000, v57
    v_cvt_pk_bf16_f32 v57, v51, v52
    v_lshlrev_b32 v51, 16, v57
    v_and_b32 v52, 0xffff0000, v57
    v_mul_f32 v49, v49, v36
    v_mul_f32 v50, v50, v37
    v_mul_f32 v51, v51, v38
    v_mul_f32 v52, v52, v39
    v_cvt_pk_bf16_f32 v57, v49, v50
    v_lshlrev_b32 v49, 16, v57
    v_and_b32 v50, 0xffff0000, v57
    v_cvt_pk_bf16_f32 v57, v51, v52
    v_lshlrev_b32 v51, 16, v57
    v_and_b32 v52, 0xffff0000, v57
    v_lshlrev_b32 v53, 16, v42
    v_and_b32 v54, 0xffff0000, v42
    v_lshlrev_b32 v55, 16, v43
    v_and_b32 v56, 0xffff0000, v43
    v_add_f32 v49, v49, v53
    v_add_f32 v50, v50, v54
    v_add_f32 v51, v51, v55
    v_add_f32 v52, v52, v56
    v_cvt_pk_bf16_f32 v46, v49, v50
    v_cvt_pk_bf16_f32 v47, v51, v52
    s_mov_b64 exec, s[64:65]
    global_store_dwordx4 v2, v[44:47], s[16:17]
gem_acc_kernel_fin:
gem_acc_kernel_end:
    s_endpgm
.section .rodata,"a"
.p2align 6
.amdhsa_kernel gem_part_kernel
  .amdhsa_next_free_vgpr 128
  .amdhsa_next_free_sgpr 88
  .amdhsa_accum_offset 128
  .amdhsa_group_segment_fixed_size 0
  .amdhsa_kernarg_size 112
  .amdhsa_user_sgpr_count 2
  .amdhsa_user_sgpr_kernarg_segment_ptr 1
  .amdhsa_system_sgpr_workgroup_id_x 1
.end_amdhsa_kernel
.p2align 6
.amdhsa_kernel gem_acc_kernel
  .amdhsa_next_free_vgpr 128
  .amdhsa_next_free_sgpr 100
  .amdhsa_accum_offset 128
  .amdhsa_group_segment_fixed_size 0
  .amdhsa_kernarg_size 112
  .amdhsa_user_sgpr_count 2
  .amdhsa_user_sgpr_kernarg_segment_ptr 1
  .amdhsa_system_sgpr_workgroup_id_x 1
.end_amdhsa_kernel
```
